```python
import torch

def _softmax(x, axis=-1):
    return torch.softmax(x, dim=axis)
def _gelu(x):
    return torch.nn.functional.gelu(x, approximate="tanh")
def _silu(x):
    return torch.nn.functional.silu(x)
def _sigmoid(x):
    return torch.sigmoid(x)
def _layernorm(x, axis=-1, eps=1e-5):
    m = x.mean(dim=axis, keepdim=True)
    v = x.var(dim=axis, keepdim=True, unbiased=False)
    return (x - m) / torch.sqrt(v + eps)
def _scatter_add(tgt, idx, src, axis=0):
    return tgt.clone().index_add_(axis, idx, src)
def _segment_sum(src, seg, n):
    out = torch.zeros((n,) + src.shape[1:], dtype=src.dtype)
    return out.index_add_(0, seg, src)
def _pad(x, pw):
    flat = tuple(v for pair in reversed(pw) for v in pair)
    return torch.nn.functional.pad(x, flat)

kernel_name = 'sequential_preLN__sliding_block_cached__geglu_ffn__decode'

def setup_inputs():

    _w = (lambda a: (lambda t: t.to(torch.bfloat16) if t.is_floating_point() else t)(torch.as_tensor(a)))
    def _A_setup():
        B, Sq, D = 2, 1, 640
        Hq, Hkv, Sk, Dh = 32, 32, 8192, 192
        assert Hq % Hkv == 0, (Hq, Hkv)
        return {
            "x": _w((lambda *s: torch.randn(*s, dtype=torch.bfloat16) * 0.05)(B, Sq, D)),
            "k_cache": _w((lambda *s: torch.randn(*s, dtype=torch.bfloat16) * 3.2)(B, Hkv, Sk, Dh)),
            "v_cache": _w((lambda *s: torch.randn(*s, dtype=torch.bfloat16) * 0.4)(B, Hkv, Sk, Dh)),
            "wq": _w((lambda *s: torch.randn(*s, dtype=torch.bfloat16) * 3.2)(D, Hq * Dh) * (D ** -0.5)),
            "wo": _w((lambda *s: torch.randn(*s, dtype=torch.bfloat16) * 0.4)(Hq * Dh, D) * ((Hq * Dh) ** -0.5)),
        }
    _A_in = _A_setup()

    def _B_setup():
        B, S, D, F = 2, 1, 640, 1536
        return {
            "x": _w((lambda *s: torch.randn(*s, dtype=torch.bfloat16) * 0.05)(B, S, D)),
            "w_gate": _w((lambda *s: torch.randn(*s, dtype=torch.bfloat16) * 0.05)(D, F)),
            "w_up": _w((lambda *s: torch.randn(*s, dtype=torch.bfloat16) * 0.05)(D, F)),
            "w_down": _w((lambda *s: torch.randn(*s, dtype=torch.bfloat16) * 0.05)(F, D)),
        }
    _B_in = _B_setup()

    return {
        "A_x": _A_in["x"],
        "A_k_cache": _A_in["k_cache"],
        "A_v_cache": _A_in["v_cache"],
        "A_wq": _A_in["wq"],
        "A_wo": _A_in["wo"],
        "B_x": _B_in["x"],
        "B_w_gate": _B_in["w_gate"],
        "B_w_up": _B_in["w_up"],
        "B_w_down": _B_in["w_down"],
    }

def reference(A_x, A_k_cache, A_v_cache, A_wq, A_wo, B_x, B_w_gate, B_w_up, B_w_down):
    def _A_ref(x, k_cache, v_cache, wq, wo):
        B, Sq, D = x.shape
        Hq, Dh = 32, 192
        Hkv, Sk = k_cache.shape[1], k_cache.shape[2]
        W = min(4096, max(256, Sk // 4))
        rep = Hq // Hkv
        q = (lambda x, *d: x.permute(*d))((x @ wq).reshape(B, Sq, Hq, Dh), 0, 2, 1, 3)
        k = (lambda x, n, axis: torch.repeat_interleave(x, n, dim=axis))(k_cache[:, :, Sk - W:, :], rep, axis=1)
        v = (lambda x, n, axis: torch.repeat_interleave(x, n, dim=axis))(v_cache[:, :, Sk - W:, :], rep, axis=1)
        scores = torch.einsum("bhqd,bhkd->bhqk", q, k) * (Dh ** -0.5)
        p = _softmax(scores, axis=-1)
        o = torch.einsum("bhqk,bhkd->bhqd", p, v)
        return (lambda x, *d: x.permute(*d))(o, 0, 2, 1, 3).reshape(B, Sq, Hq * Dh) @ wo

    def _B_ref(x, w_gate, w_up, w_down):
        return (_gelu(x @ w_gate) * (x @ w_up)) @ w_down

    x = A_x
    h = x + _A_ref(_layernorm(x, axis=-1), A_k_cache, A_v_cache, A_wq, A_wo)
    h2 = h + _B_ref(_layernorm(h, axis=-1), B_w_gate, B_w_up, B_w_down)
    return h2
```

```asm
; @launch grid=(256,1,1) block=(512,1,1) lds=122880
.amdgcn_target "amdgcn-amd-amdhsa--gfx950"
.text
.globl sequential_preLN__sliding_block_cached__geglu_ffn__decode_kernel
.p2align 8
.type sequential_preLN__sliding_block_cached__geglu_ffn__decode_kernel,@function
sequential_preLN__sliding_block_cached__geglu_ffn__decode_kernel:
    s_cmp_ge_u32 s2, 256
    s_cbranch_scc1 L_end
    s_load_dwordx16 s[76:91], s[0:1], 0
    s_load_dwordx8 s[92:99], s[0:1], 64
    v_lshrrev_b32 v2, 6, v0
    v_and_b32 v1, 63, v0
    s_nop 0
    v_readfirstlane_b32 s14, v2
    s_and_b32 s19, s2, 7
    s_lshr_b32 s16, s2, 3
    s_and_b32 s17, s16, 3
    s_lshl_b32 s15, s19, 2
    s_add_u32 s15, s15, s17
    s_lshr_b32 s17, s16, 2
    s_and_b32 s17, s17, 1
    s_lshr_b32 s18, s16, 3
    s_sub_u32 s13, s16, 20
    s_lshl_b32 s13, s13, 3
    s_add_u32 s13, s13, s19
    s_waitcnt lgkmcnt(0)

    s_mov_b32 s20, s76
    s_and_b32 s21, s77, 0xffff
    s_mov_b32 s22, 2560
    s_mov_b32 s23, 0x00020000

    s_mov_b32 s24, s78
    s_and_b32 s25, s79, 0xffff
    s_mov_b32 s26, 201326592
    s_mov_b32 s27, 0x00020000

    s_mov_b32 s28, s80
    s_and_b32 s29, s81, 0xffff
    s_mov_b32 s30, 201326592
    s_mov_b32 s31, 0x00020000

    s_mov_b32 s32, s82
    s_and_b32 s33, s83, 0xffff
    s_mov_b32 s34, 7864320
    s_mov_b32 s35, 0x00020000

    s_mov_b32 s36, s98
    s_and_b32 s37, s99, 0xffff
    s_mov_b32 s38, 1572864
    s_mov_b32 s39, 0x00020000

    s_mov_b32 s52, s84
    s_and_b32 s53, s85, 0xffff
    s_mov_b32 s54, 7864320
    s_mov_b32 s55, 0x00020000

    s_mov_b32 s56, s88
    s_and_b32 s57, s89, 0xffff
    s_mov_b32 s58, 1966080
    s_mov_b32 s59, 0x00020000

    s_mov_b32 s60, s90
    s_and_b32 s61, s91, 0xffff
    s_mov_b32 s62, 1966080
    s_mov_b32 s63, 0x00020000

    s_mov_b32 s64, s92
    s_and_b32 s65, s93, 0xffff
    s_mov_b32 s66, 1966080
    s_mov_b32 s67, 0x00020000

    s_mov_b32 s68, s94
    s_and_b32 s69, s95, 0xffff
    s_mov_b32 s70, 2560
    s_mov_b32 s71, 0x00020000

    s_mov_b32 s72, s96
    s_and_b32 s73, s97, 0xffff
    s_mov_b32 s74, 256
    s_mov_b32 s75, 0x00020000

    s_cmp_lt_u32 s14, 4
    s_cselect_b32 s48, s56, s60
    s_cselect_b32 s49, s57, s61
    s_mov_b32 s50, 1966080
    s_mov_b32 s51, 0x00020000

    v_mov_b32 v4, -1
    v_mov_b32 v5, -1
    v_mov_b32 v6, -1
    v_mov_b32 v7, -1
    v_lshlrev_b32 v8, 4, v1
    s_lshl_b32 s42, s17, 5
    s_add_u32 s42, s42, s15
    s_lshl_b32 s42, s42, 2
    s_add_u32 s42, s42, s18
    s_lshl_b32 s42, s42, 10
    s_lshr_b32 s43, s16, 2
    s_mul_i32 s43, s43, 49152
    s_mul_i32 s44, s15, 768
    s_add_u32 s43, s43, s44
    s_add_u32 s43, s43, 1048576
    s_mov_b32 s40, s42
    s_mov_b32 s41, 64
    s_cmp_eq_u32 s14, 0
    s_cbranch_scc1 L_clr_go
    s_mov_b32 s40, s43
    s_mov_b32 s41, 48
    s_cmp_eq_u32 s14, 1
    s_cbranch_scc1 L_clr_go
    s_add_u32 s40, s43, 24576
    s_cmp_eq_u32 s14, 2
    s_cbranch_scc1 L_clr_go
    s_cmp_ge_u32 s16, 20
    s_cbranch_scc1 L_clr_ffn
    s_mov_b32 s41, 0
    s_cmp_ge_u32 s14, 5
    s_cbranch_scc1 L_clr_go
    s_mul_i32 s40, s19, 5120
    s_lshl_b32 s44, s16, 7
    s_add_u32 s40, s40, s44
    s_add_u32 s40, s40, 262144
    s_sub_u32 s44, s14, 3
    s_mul_i32 s44, s44, 2560
    s_add_u32 s40, s40, s44
    s_mov_b32 s41, 8
    s_branch L_clr_go

L_clr_ffn:
    s_mul_i32 s40, s13, 5120
    s_sub_u32 s44, s14, 3
    s_lshl_b32 s44, s44, 10
    s_add_u32 s40, s40, s44
    s_add_u32 s40, s40, 327680
    s_mov_b32 s41, 64
    s_cmp_lg_u32 s13, 0
    s_cbranch_scc1 L_clr_go
    s_add_u32 s45, s44, 851968
    buffer_store_dwordx4 v[4:7], v8, s[36:39], s45 offen sc1

L_clr_go:
    v_cmp_gt_u32 vcc, s41, v1
    s_and_saveexec_b64 s[44:45], vcc
    s_cbranch_execz L_clr_skip
    buffer_store_dwordx4 v[4:7], v8, s[36:39], s40 offen sc1

L_clr_skip:
    s_mov_b64 exec, s[44:45]
    v_add_u32 v8, 0, v1
    v_mul_u32_u24 v9, 683, v8
    v_lshrrev_b32 v9, 14, v9
    v_mul_u32_u24 v10, 24, v9
    v_sub_u32 v10, v8, v10
    v_lshlrev_b32 v2, 4, v10
    v_lshlrev_b32 v5, 2, v9

    v_add_u32 v8, 64, v1
    v_mul_u32_u24 v9, 683, v8
    v_lshrrev_b32 v9, 14, v9
    v_mul_u32_u24 v10, 24, v9
    v_sub_u32 v10, v8, v10
    v_lshlrev_b32 v3, 4, v10
    v_lshlrev_b32 v6, 2, v9

    v_add_u32 v8, 128, v1
    v_mul_u32_u24 v9, 683, v8
    v_lshrrev_b32 v9, 14, v9
    v_mul_u32_u24 v10, 24, v9
    v_sub_u32 v10, v8, v10
    v_lshlrev_b32 v4, 4, v10
    v_lshlrev_b32 v7, 2, v9

    v_lshlrev_b32 v8, 2, v1
    buffer_load_dword v16, v8, s[20:23], 0 offen offset:0
    buffer_load_dword v17, v8, s[20:23], 0 offen offset:256
    buffer_load_dword v18, v8, s[20:23], 0 offen offset:512
    buffer_load_dword v19, v8, s[20:23], 0 offen offset:768
    buffer_load_dword v20, v8, s[20:23], 0 offen offset:1024
    buffer_load_dword v21, v8, s[20:23], 0 offen offset:1280
    buffer_load_dword v22, v8, s[20:23], 0 offen offset:1536
    buffer_load_dword v23, v8, s[20:23], 0 offen offset:1792
    buffer_load_dword v24, v8, s[20:23], 0 offen offset:2048
    buffer_load_dword v25, v8, s[20:23], 0 offen offset:2304
    v_mul_u32_u24 v9, 683, v0
    v_lshrrev_b32 v9, 14, v9
    v_mul_u32_u24 v10, 24, v9
    v_sub_u32 v10, v0, v10
    v_min_u32 v11, 19, v9
    v_mul_u32_u24 v12, 12288, v11
    v_lshlrev_b32 v10, 4, v10
    v_add_u32 v12, v12, v10
    s_lshr_b32 s40, s16, 2
    s_mul_i32 s40, s40, 983040
    s_mul_i32 s41, s15, 384
    s_add_u32 s40, s40, s41

    buffer_load_dwordx4 v[232:235], v12, s[32:35], s40 offen
    s_add_u32 s40, s40, 245760
    buffer_load_dwordx4 v[236:239], v12, s[32:35], s40 offen
    s_add_u32 s40, s40, 245760
    buffer_load_dwordx4 v[240:243], v12, s[32:35], s40 offen
    s_add_u32 s40, s40, 245760
    buffer_load_dwordx4 v[244:247], v12, s[32:35], s40 offen
    s_barrier
    s_lshl_b32 s43, s17, 5
    s_add_u32 s43, s43, s15
    s_lshl_b32 s43, s43, 13
    s_add_u32 s43, s43, 6144
    s_lshl_b32 s44, s18, 9
    s_add_u32 s43, s43, s44
    s_lshl_b32 s44, s14, 6
    s_add_u32 s43, s43, s44
    s_mul_i32 s43, s43, 384
    v_lshlrev_b32 v249, 4, v1

    s_add_u32 s99, s43, 0
    buffer_load_dwordx4 v[40:43], v249, s[24:27], s99 offen offset:0 nt
    buffer_load_dwordx4 v[44:47], v249, s[24:27], s99 offen offset:1024 nt
    buffer_load_dwordx4 v[48:51], v249, s[24:27], s99 offen offset:2048 nt
    buffer_load_dwordx4 v[52:55], v249, s[24:27], s99 offen offset:3072 nt
    s_add_u32 s99, s43, 4096
    buffer_load_dwordx4 v[56:59], v249, s[24:27], s99 offen offset:0 nt
    buffer_load_dwordx4 v[60:63], v249, s[24:27], s99 offen offset:1024 nt
    buffer_load_dwordx4 v[64:67], v249, s[24:27], s99 offen offset:2048 nt
    buffer_load_dwordx4 v[68:71], v249, s[24:27], s99 offen offset:3072 nt
    s_add_u32 s99, s43, 8192
    buffer_load_dwordx4 v[72:75], v249, s[24:27], s99 offen offset:0 nt
    buffer_load_dwordx4 v[76:79], v249, s[24:27], s99 offen offset:1024 nt
    s_waitcnt vmcnt(10)
    v_lshlrev_b32 v8, 3, v1
    v_add_u32 v8, 102400, v8
    v_lshlrev_b32 v136, 16, v16
    v_and_b32 v137, 0xffff0000, v16

    v_lshlrev_b32 v138, 16, v17
    v_and_b32 v139, 0xffff0000, v17

    v_lshlrev_b32 v140, 16, v18
    v_and_b32 v141, 0xffff0000, v18

    v_lshlrev_b32 v142, 16, v19
    v_and_b32 v143, 0xffff0000, v19

    v_lshlrev_b32 v144, 16, v20
    v_and_b32 v145, 0xffff0000, v20

    v_add_f32 v160, v136, v137
    v_add_f32 v160, v160, v138
    v_add_f32 v160, v160, v139
    v_add_f32 v160, v160, v140
    v_add_f32 v160, v160, v141
    v_add_f32 v160, v160, v142
    v_add_f32 v160, v160, v143
    v_add_f32 v160, v160, v144
    v_add_f32 v160, v160, v145
    s_nop 1
    v_add_f32_dpp v161, v160, v160 quad_perm:[1,0,3,2] row_mask:0xf bank_mask:0xf
    s_nop 1
    v_add_f32_dpp v160, v161, v161 quad_perm:[2,3,0,1] row_mask:0xf bank_mask:0xf
    s_nop 1
    v_add_f32_dpp v161, v160, v160 row_half_mirror row_mask:0xf bank_mask:0xf
    s_nop 1
    v_add_f32_dpp v160, v161, v161 row_mirror row_mask:0xf bank_mask:0xf
    s_nop 1
    v_readlane_b32 s44, v160, 0
    v_readlane_b32 s45, v160, 16
    v_readlane_b32 s46, v160, 32
    v_readlane_b32 s47, v160, 48
    s_nop 1
    v_mov_b32 v160, s44
    v_add_f32 v160, s45, v160
    v_add_f32 v160, s46, v160
    v_add_f32 v160, s47, v160

    v_mul_f32 v160, 986500301, v160
    v_mov_b32 v162, v160

    v_cvt_pk_bf16_f32 v162, v162, v162
    v_lshlrev_b32 v162, 16, v162

    v_sub_f32 v161, v136, v160
    v_mul_f32 v163, v161, v161

    v_sub_f32 v161, v137, v160
    v_fmac_f32 v163, v161, v161

    v_sub_f32 v161, v138, v160
    v_fmac_f32 v163, v161, v161

    v_sub_f32 v161, v139, v160
    v_fmac_f32 v163, v161, v161

    v_sub_f32 v161, v140, v160
    v_fmac_f32 v163, v161, v161

    v_sub_f32 v161, v141, v160
    v_fmac_f32 v163, v161, v161

    v_sub_f32 v161, v142, v160
    v_fmac_f32 v163, v161, v161

    v_sub_f32 v161, v143, v160
    v_fmac_f32 v163, v161, v161

    v_sub_f32 v161, v144, v160
    v_fmac_f32 v163, v161, v161

    v_sub_f32 v161, v145, v160
    v_fmac_f32 v163, v161, v161

    s_nop 1
    v_add_f32_dpp v161, v163, v163 quad_perm:[1,0,3,2] row_mask:0xf bank_mask:0xf
    s_nop 1
    v_add_f32_dpp v163, v161, v161 quad_perm:[2,3,0,1] row_mask:0xf bank_mask:0xf
    s_nop 1
    v_add_f32_dpp v161, v163, v163 row_half_mirror row_mask:0xf bank_mask:0xf
    s_nop 1
    v_add_f32_dpp v163, v161, v161 row_mirror row_mask:0xf bank_mask:0xf
    s_nop 1
    v_readlane_b32 s44, v163, 0
    v_readlane_b32 s45, v163, 16
    v_readlane_b32 s46, v163, 32
    v_readlane_b32 s47, v163, 48
    s_nop 1
    v_mov_b32 v163, s44
    v_add_f32 v163, s45, v163
    v_add_f32 v163, s46, v163
    v_add_f32 v163, s47, v163

    v_mul_f32 v163, 986500301, v163
    v_cvt_pk_bf16_f32 v163, v163, v163
    v_lshlrev_b32 v163, 16, v163

    v_add_f32 v163, 925353388, v163
    v_cvt_pk_bf16_f32 v163, v163, v163
    v_lshlrev_b32 v163, 16, v163

    v_sqrt_f32 v163, v163
    s_nop 0
    v_cvt_pk_bf16_f32 v163, v163, v163
    v_lshlrev_b32 v163, 16, v163

    v_rcp_f32 v163, v163
    s_nop 0
    v_sub_f32 v136, v136, v162
    v_cvt_pk_bf16_f32 v136, v136, v136
    v_lshlrev_b32 v136, 16, v136

    v_mul_f32 v136, v136, v163
    v_cvt_pk_bf16_f32 v136, v136, v136
    v_lshlrev_b32 v136, 16, v136

    v_sub_f32 v137, v137, v162
    v_cvt_pk_bf16_f32 v137, v137, v137
    v_lshlrev_b32 v137, 16, v137

    v_mul_f32 v137, v137, v163
    v_cvt_pk_bf16_f32 v137, v137, v137
    v_lshlrev_b32 v137, 16, v137

    v_sub_f32 v138, v138, v162
    v_cvt_pk_bf16_f32 v138, v138, v138
    v_lshlrev_b32 v138, 16, v138

    v_mul_f32 v138, v138, v163
    v_cvt_pk_bf16_f32 v138, v138, v138
    v_lshlrev_b32 v138, 16, v138

    v_sub_f32 v139, v139, v162
    v_cvt_pk_bf16_f32 v139, v139, v139
    v_lshlrev_b32 v139, 16, v139

    v_mul_f32 v139, v139, v163
    v_cvt_pk_bf16_f32 v139, v139, v139
    v_lshlrev_b32 v139, 16, v139

    v_sub_f32 v140, v140, v162
    v_cvt_pk_bf16_f32 v140, v140, v140
    v_lshlrev_b32 v140, 16, v140

    v_mul_f32 v140, v140, v163
    v_cvt_pk_bf16_f32 v140, v140, v140
    v_lshlrev_b32 v140, 16, v140

    v_sub_f32 v141, v141, v162
    v_cvt_pk_bf16_f32 v141, v141, v141
    v_lshlrev_b32 v141, 16, v141

    v_mul_f32 v141, v141, v163
    v_cvt_pk_bf16_f32 v141, v141, v141
    v_lshlrev_b32 v141, 16, v141

    v_sub_f32 v142, v142, v162
    v_cvt_pk_bf16_f32 v142, v142, v142
    v_lshlrev_b32 v142, 16, v142

    v_mul_f32 v142, v142, v163
    v_cvt_pk_bf16_f32 v142, v142, v142
    v_lshlrev_b32 v142, 16, v142

    v_sub_f32 v143, v143, v162
    v_cvt_pk_bf16_f32 v143, v143, v143
    v_lshlrev_b32 v143, 16, v143

    v_mul_f32 v143, v143, v163
    v_cvt_pk_bf16_f32 v143, v143, v143
    v_lshlrev_b32 v143, 16, v143

    v_sub_f32 v144, v144, v162
    v_cvt_pk_bf16_f32 v144, v144, v144
    v_lshlrev_b32 v144, 16, v144

    v_mul_f32 v144, v144, v163
    v_cvt_pk_bf16_f32 v144, v144, v144
    v_lshlrev_b32 v144, 16, v144

    v_sub_f32 v145, v145, v162
    v_cvt_pk_bf16_f32 v145, v145, v145
    v_lshlrev_b32 v145, 16, v145

    v_mul_f32 v145, v145, v163
    v_cvt_pk_bf16_f32 v145, v145, v145
    v_lshlrev_b32 v145, 16, v145

    ds_write_b64 v8, v[136:137] offset:0
    ds_write_b64 v8, v[138:139] offset:512
    ds_write_b64 v8, v[140:141] offset:1024
    ds_write_b64 v8, v[142:143] offset:1536
    ds_write_b64 v8, v[144:145] offset:2048
    v_lshlrev_b32 v146, 16, v21
    v_and_b32 v147, 0xffff0000, v21

    v_lshlrev_b32 v148, 16, v22
    v_and_b32 v149, 0xffff0000, v22

    v_lshlrev_b32 v150, 16, v23
    v_and_b32 v151, 0xffff0000, v23

    v_lshlrev_b32 v152, 16, v24
    v_and_b32 v153, 0xffff0000, v24

    v_lshlrev_b32 v154, 16, v25
    v_and_b32 v155, 0xffff0000, v25

    v_add_f32 v160, v146, v147
    v_add_f32 v160, v160, v148
    v_add_f32 v160, v160, v149
    v_add_f32 v160, v160, v150
    v_add_f32 v160, v160, v151
    v_add_f32 v160, v160, v152
    v_add_f32 v160, v160, v153
    v_add_f32 v160, v160, v154
    v_add_f32 v160, v160, v155
    s_nop 1
    v_add_f32_dpp v161, v160, v160 quad_perm:[1,0,3,2] row_mask:0xf bank_mask:0xf
    s_nop 1
    v_add_f32_dpp v160, v161, v161 quad_perm:[2,3,0,1] row_mask:0xf bank_mask:0xf
    s_nop 1
    v_add_f32_dpp v161, v160, v160 row_half_mirror row_mask:0xf bank_mask:0xf
    s_nop 1
    v_add_f32_dpp v160, v161, v161 row_mirror row_mask:0xf bank_mask:0xf
    s_nop 1
    v_readlane_b32 s44, v160, 0
    v_readlane_b32 s45, v160, 16
    v_readlane_b32 s46, v160, 32
    v_readlane_b32 s47, v160, 48
    s_nop 1
    v_mov_b32 v160, s44
    v_add_f32 v160, s45, v160
    v_add_f32 v160, s46, v160
    v_add_f32 v160, s47, v160

    v_mul_f32 v160, 986500301, v160
    v_mov_b32 v162, v160

    v_cvt_pk_bf16_f32 v162, v162, v162
    v_lshlrev_b32 v162, 16, v162

    v_sub_f32 v161, v146, v160
    v_mul_f32 v163, v161, v161

    v_sub_f32 v161, v147, v160
    v_fmac_f32 v163, v161, v161

    v_sub_f32 v161, v148, v160
    v_fmac_f32 v163, v161, v161

    v_sub_f32 v161, v149, v160
    v_fmac_f32 v163, v161, v161

    v_sub_f32 v161, v150, v160
    v_fmac_f32 v163, v161, v161

    v_sub_f32 v161, v151, v160
    v_fmac_f32 v163, v161, v161

    v_sub_f32 v161, v152, v160
    v_fmac_f32 v163, v161, v161

    v_sub_f32 v161, v153, v160
    v_fmac_f32 v163, v161, v161

    v_sub_f32 v161, v154, v160
    v_fmac_f32 v163, v161, v161

    v_sub_f32 v161, v155, v160
    v_fmac_f32 v163, v161, v161

    s_nop 1
    v_add_f32_dpp v161, v163, v163 quad_perm:[1,0,3,2] row_mask:0xf bank_mask:0xf
    s_nop 1
    v_add_f32_dpp v163, v161, v161 quad_perm:[2,3,0,1] row_mask:0xf bank_mask:0xf
    s_nop 1
    v_add_f32_dpp v161, v163, v163 row_half_mirror row_mask:0xf bank_mask:0xf
    s_nop 1
    v_add_f32_dpp v163, v161, v161 row_mirror row_mask:0xf bank_mask:0xf
    s_nop 1
    v_readlane_b32 s44, v163, 0
    v_readlane_b32 s45, v163, 16
    v_readlane_b32 s46, v163, 32
    v_readlane_b32 s47, v163, 48
    s_nop 1
    v_mov_b32 v163, s44
    v_add_f32 v163, s45, v163
    v_add_f32 v163, s46, v163
    v_add_f32 v163, s47, v163

    v_mul_f32 v163, 986500301, v163
    v_cvt_pk_bf16_f32 v163, v163, v163
    v_lshlrev_b32 v163, 16, v163

    v_add_f32 v163, 925353388, v163
    v_cvt_pk_bf16_f32 v163, v163, v163
    v_lshlrev_b32 v163, 16, v163

    v_sqrt_f32 v163, v163
    s_nop 0
    v_cvt_pk_bf16_f32 v163, v163, v163
    v_lshlrev_b32 v163, 16, v163

    v_rcp_f32 v163, v163
    s_nop 0
    v_sub_f32 v146, v146, v162
    v_cvt_pk_bf16_f32 v146, v146, v146
    v_lshlrev_b32 v146, 16, v146

    v_mul_f32 v146, v146, v163
    v_cvt_pk_bf16_f32 v146, v146, v146
    v_lshlrev_b32 v146, 16, v146

    v_sub_f32 v147, v147, v162
    v_cvt_pk_bf16_f32 v147, v147, v147
    v_lshlrev_b32 v147, 16, v147

    v_mul_f32 v147, v147, v163
    v_cvt_pk_bf16_f32 v147, v147, v147
    v_lshlrev_b32 v147, 16, v147

    v_sub_f32 v148, v148, v162
    v_cvt_pk_bf16_f32 v148, v148, v148
    v_lshlrev_b32 v148, 16, v148

    v_mul_f32 v148, v148, v163
    v_cvt_pk_bf16_f32 v148, v148, v148
    v_lshlrev_b32 v148, 16, v148

    v_sub_f32 v149, v149, v162
    v_cvt_pk_bf16_f32 v149, v149, v149
    v_lshlrev_b32 v149, 16, v149

    v_mul_f32 v149, v149, v163
    v_cvt_pk_bf16_f32 v149, v149, v149
    v_lshlrev_b32 v149, 16, v149

    v_sub_f32 v150, v150, v162
    v_cvt_pk_bf16_f32 v150, v150, v150
    v_lshlrev_b32 v150, 16, v150

    v_mul_f32 v150, v150, v163
    v_cvt_pk_bf16_f32 v150, v150, v150
    v_lshlrev_b32 v150, 16, v150

    v_sub_f32 v151, v151, v162
    v_cvt_pk_bf16_f32 v151, v151, v151
    v_lshlrev_b32 v151, 16, v151

    v_mul_f32 v151, v151, v163
    v_cvt_pk_bf16_f32 v151, v151, v151
    v_lshlrev_b32 v151, 16, v151

    v_sub_f32 v152, v152, v162
    v_cvt_pk_bf16_f32 v152, v152, v152
    v_lshlrev_b32 v152, 16, v152

    v_mul_f32 v152, v152, v163
    v_cvt_pk_bf16_f32 v152, v152, v152
    v_lshlrev_b32 v152, 16, v152

    v_sub_f32 v153, v153, v162
    v_cvt_pk_bf16_f32 v153, v153, v153
    v_lshlrev_b32 v153, 16, v153

    v_mul_f32 v153, v153, v163
    v_cvt_pk_bf16_f32 v153, v153, v153
    v_lshlrev_b32 v153, 16, v153

    v_sub_f32 v154, v154, v162
    v_cvt_pk_bf16_f32 v154, v154, v154
    v_lshlrev_b32 v154, 16, v154

    v_mul_f32 v154, v154, v163
    v_cvt_pk_bf16_f32 v154, v154, v154
    v_lshlrev_b32 v154, 16, v154

    v_sub_f32 v155, v155, v162
    v_cvt_pk_bf16_f32 v155, v155, v155
    v_lshlrev_b32 v155, 16, v155

    v_mul_f32 v155, v155, v163
    v_cvt_pk_bf16_f32 v155, v155, v155
    v_lshlrev_b32 v155, 16, v155

    ds_write_b64 v8, v[146:147] offset:2560
    ds_write_b64 v8, v[148:149] offset:3072
    ds_write_b64 v8, v[150:151] offset:3584
    ds_write_b64 v8, v[152:153] offset:4096
    ds_write_b64 v8, v[154:155] offset:4608
    s_lshr_b32 s40, s16, 2
    s_mul_i32 s40, s40, 320
    s_add_u32 s40, s40, 102400
    v_lshlrev_b32 v8, 2, v11
    v_add_u32 v8, s40, v8
    s_waitcnt lgkmcnt(0)

    v_mov_b32 v16, 0
    v_mov_b32 v17, 0
    v_mov_b32 v18, 0
    v_mov_b32 v19, 0
    v_mov_b32 v20, 0
    v_mov_b32 v21, 0
    v_mov_b32 v22, 0
    v_mov_b32 v23, 0
    v_mov_b32 v24, 0
    v_mov_b32 v25, 0
    v_mov_b32 v26, 0
    v_mov_b32 v27, 0
    v_mov_b32 v28, 0
    v_mov_b32 v29, 0
    v_mov_b32 v30, 0
    v_mov_b32 v31, 0
    ds_read_b32 v12, v8 offset:0
    ds_read_b32 v13, v8 offset:2560
    s_waitcnt lgkmcnt(0)

    v_lshlrev_b32 v14, 16, v232
    v_and_b32 v15, 0xffff0000, v232
    v_fmac_f32 v16, v12, v14
    v_fmac_f32 v17, v12, v15
    v_fmac_f32 v24, v13, v14
    v_fmac_f32 v25, v13, v15

    v_lshlrev_b32 v14, 16, v233
    v_and_b32 v15, 0xffff0000, v233
    v_fmac_f32 v18, v12, v14
    v_fmac_f32 v19, v12, v15
    v_fmac_f32 v26, v13, v14
    v_fmac_f32 v27, v13, v15

    v_lshlrev_b32 v14, 16, v234
    v_and_b32 v15, 0xffff0000, v234
    v_fmac_f32 v20, v12, v14
    v_fmac_f32 v21, v12, v15
    v_fmac_f32 v28, v13, v14
    v_fmac_f32 v29, v13, v15

    v_lshlrev_b32 v14, 16, v235
    v_and_b32 v15, 0xffff0000, v235
    v_fmac_f32 v22, v12, v14
    v_fmac_f32 v23, v12, v15
    v_fmac_f32 v30, v13, v14
    v_fmac_f32 v31, v13, v15

    ds_read_b32 v12, v8 offset:80
    ds_read_b32 v13, v8 offset:2640
    s_waitcnt lgkmcnt(0)

    v_lshlrev_b32 v14, 16, v236
    v_and_b32 v15, 0xffff0000, v236
    v_fmac_f32 v16, v12, v14
    v_fmac_f32 v17, v12, v15
    v_fmac_f32 v24, v13, v14
    v_fmac_f32 v25, v13, v15

    v_lshlrev_b32 v14, 16, v237
    v_and_b32 v15, 0xffff0000, v237
    v_fmac_f32 v18, v12, v14
    v_fmac_f32 v19, v12, v15
    v_fmac_f32 v26, v13, v14
    v_fmac_f32 v27, v13, v15

    v_lshlrev_b32 v14, 16, v238
    v_and_b32 v15, 0xffff0000, v238
    v_fmac_f32 v20, v12, v14
    v_fmac_f32 v21, v12, v15
    v_fmac_f32 v28, v13, v14
    v_fmac_f32 v29, v13, v15

    v_lshlrev_b32 v14, 16, v239
    v_and_b32 v15, 0xffff0000, v239
    v_fmac_f32 v22, v12, v14
    v_fmac_f32 v23, v12, v15
    v_fmac_f32 v30, v13, v14
    v_fmac_f32 v31, v13, v15

    ds_read_b32 v12, v8 offset:160
    ds_read_b32 v13, v8 offset:2720
    s_waitcnt lgkmcnt(0)

    v_lshlrev_b32 v14, 16, v240
    v_and_b32 v15, 0xffff0000, v240
    v_fmac_f32 v16, v12, v14
    v_fmac_f32 v17, v12, v15
    v_fmac_f32 v24, v13, v14
    v_fmac_f32 v25, v13, v15

    v_lshlrev_b32 v14, 16, v241
    v_and_b32 v15, 0xffff0000, v241
    v_fmac_f32 v18, v12, v14
    v_fmac_f32 v19, v12, v15
    v_fmac_f32 v26, v13, v14
    v_fmac_f32 v27, v13, v15

    v_lshlrev_b32 v14, 16, v242
    v_and_b32 v15, 0xffff0000, v242
    v_fmac_f32 v20, v12, v14
    v_fmac_f32 v21, v12, v15
    v_fmac_f32 v28, v13, v14
    v_fmac_f32 v29, v13, v15

    v_lshlrev_b32 v14, 16, v243
    v_and_b32 v15, 0xffff0000, v243
    v_fmac_f32 v22, v12, v14
    v_fmac_f32 v23, v12, v15
    v_fmac_f32 v30, v13, v14
    v_fmac_f32 v31, v13, v15

    ds_read_b32 v12, v8 offset:240
    ds_read_b32 v13, v8 offset:2800
    s_waitcnt lgkmcnt(0)

    v_lshlrev_b32 v14, 16, v244
    v_and_b32 v15, 0xffff0000, v244
    v_fmac_f32 v16, v12, v14
    v_fmac_f32 v17, v12, v15
    v_fmac_f32 v24, v13, v14
    v_fmac_f32 v25, v13, v15

    v_lshlrev_b32 v14, 16, v245
    v_and_b32 v15, 0xffff0000, v245
    v_fmac_f32 v18, v12, v14
    v_fmac_f32 v19, v12, v15
    v_fmac_f32 v26, v13, v14
    v_fmac_f32 v27, v13, v15

    v_lshlrev_b32 v14, 16, v246
    v_and_b32 v15, 0xffff0000, v246
    v_fmac_f32 v20, v12, v14
    v_fmac_f32 v21, v12, v15
    v_fmac_f32 v28, v13, v14
    v_fmac_f32 v29, v13, v15

    v_lshlrev_b32 v14, 16, v247
    v_and_b32 v15, 0xffff0000, v247
    v_fmac_f32 v22, v12, v14
    v_fmac_f32 v23, v12, v15
    v_fmac_f32 v30, v13, v14
    v_fmac_f32 v31, v13, v15

    v_cmp_gt_u32 vcc, 480, v0
    s_and_saveexec_b64 s[44:45], vcc
    v_lshlrev_b32 v8, 6, v0

    ds_write_b128 v8, v[16:19] offset:4096
    ds_write_b128 v8, v[20:23] offset:4112
    ds_write_b128 v8, v[24:27] offset:4128
    ds_write_b128 v8, v[28:31] offset:4144
    s_mov_b64 exec, s[44:45]
    s_waitcnt lgkmcnt(0)
    s_barrier
    s_cmp_lg_u32 s14, 0
    s_cbranch_scc1 L_noadd
    v_mov_b32 v8, 1
    s_lshl_b32 s40, s19, 5
    v_mov_b32 v9, s40
    v_cmp_eq_u32 vcc, 0, v1
    s_and_saveexec_b64 s[44:45], vcc
    buffer_atomic_add v8, v9, s[72:75], 0 offen
    s_mov_b64 exec, s[44:45]

L_noadd:
    s_cmp_ge_u32 s14, 6
    s_cbranch_scc1 L_qp_skip
    v_cmp_le_u32 vcc, 192, v0
    s_nop 1
    v_cndmask_b32 v8, 0, 1, vcc
    v_mul_u32_u24 v9, 192, v8
    v_sub_u32 v9, v0, v9
    v_lshrrev_b32 v10, 3, v9
    v_and_b32 v11, 7, v9
    v_lshlrev_b32 v10, 6, v10
    v_lshlrev_b32 v11, 2, v11
    v_add_u32 v10, v10, v11
    v_lshlrev_b32 v11, 5, v8
    v_add_u32 v10, v10, v11

    ds_read_b32 v16, v10 offset:4096
    ds_read_b32 v17, v10 offset:5632
    ds_read_b32 v18, v10 offset:7168
    ds_read_b32 v19, v10 offset:8704
    ds_read_b32 v20, v10 offset:10240
    ds_read_b32 v21, v10 offset:11776
    ds_read_b32 v22, v10 offset:13312
    ds_read_b32 v23, v10 offset:14848
    ds_read_b32 v24, v10 offset:16384
    ds_read_b32 v25, v10 offset:17920
    ds_read_b32 v26, v10 offset:19456
    ds_read_b32 v27, v10 offset:20992
    ds_read_b32 v28, v10 offset:22528
    ds_read_b32 v29, v10 offset:24064
    ds_read_b32 v30, v10 offset:25600
    ds_read_b32 v31, v10 offset:27136
    ds_read_b32 v32, v10 offset:28672
    ds_read_b32 v33, v10 offset:30208
    ds_read_b32 v34, v10 offset:31744
    ds_read_b32 v35, v10 offset:33280
    s_waitcnt lgkmcnt(0)
    v_add_f32 v16, v16, v17
    v_add_f32 v16, v16, v18
    v_add_f32 v16, v16, v19
    v_add_f32 v16, v16, v20
    v_add_f32 v16, v16, v21
    v_add_f32 v16, v16, v22
    v_add_f32 v16, v16, v23
    v_add_f32 v16, v16, v24
    v_add_f32 v16, v16, v25
    v_add_f32 v16, v16, v26
    v_add_f32 v16, v16, v27
    v_add_f32 v16, v16, v28
    v_add_f32 v16, v16, v29
    v_add_f32 v16, v16, v30
    v_add_f32 v16, v16, v31
    v_add_f32 v16, v16, v32
    v_add_f32 v16, v16, v33
    v_add_f32 v16, v16, v34
    v_add_f32 v16, v16, v35
    v_mul_u32_u24 v11, 24576, v8
    v_lshlrev_b32 v9, 2, v9
    v_add_u32 v11, v11, v9
    s_lshr_b32 s40, s16, 2
    s_mul_i32 s40, s40, 49152
    s_mul_i32 s41, s15, 768
    s_add_u32 s40, s40, s41
    s_add_u32 s40, s40, 1048576
    buffer_store_dword v16, v11, s[36:39], s40 offen sc1

L_qp_skip:
    s_waitcnt vmcnt(9)
    buffer_load_dwordx4 v[80:83], v249, s[24:27], s99 offen offset:2048 nt
    s_waitcnt vmcnt(9)
    buffer_load_dwordx4 v[84:87], v249, s[24:27], s99 offen offset:3072 nt
    s_add_u32 s99, s43, 12288
    s_waitcnt vmcnt(9)
    buffer_load_dwordx4 v[88:91], v249, s[24:27], s99 offen offset:0 nt
    s_waitcnt vmcnt(9)
    buffer_load_dwordx4 v[92:95], v249, s[24:27], s99 offen offset:1024 nt
    s_waitcnt vmcnt(9)
    buffer_load_dwordx4 v[96:99], v249, s[24:27], s99 offen offset:2048 nt
    s_waitcnt vmcnt(9)
    buffer_load_dwordx4 v[100:103], v249, s[24:27], s99 offen offset:3072 nt
    s_add_u32 s99, s43, 16384
    s_waitcnt vmcnt(9)
    buffer_load_dwordx4 v[104:107], v249, s[24:27], s99 offen offset:0 nt
    s_waitcnt vmcnt(9)
    buffer_load_dwordx4 v[108:111], v249, s[24:27], s99 offen offset:1024 nt
    s_waitcnt vmcnt(9)
    buffer_load_dwordx4 v[112:115], v249, s[24:27], s99 offen offset:2048 nt
    s_waitcnt vmcnt(9)
    buffer_load_dwordx4 v[116:119], v249, s[24:27], s99 offen offset:3072 nt
    s_add_u32 s99, s43, 20480
    s_waitcnt vmcnt(9)
    buffer_load_dwordx4 v[120:123], v249, s[24:27], s99 offen offset:0 nt
    s_waitcnt vmcnt(9)
    buffer_load_dwordx4 v[124:127], v249, s[24:27], s99 offen offset:1024 nt
    s_waitcnt vmcnt(9)
    buffer_load_dwordx4 v[128:131], v249, s[24:27], s99 offen offset:2048 nt
    s_waitcnt vmcnt(9)
    buffer_load_dwordx4 v[132:135], v249, s[24:27], s99 offen offset:3072 nt
    s_add_u32 s99, s43, 0
    s_waitcnt vmcnt(9)
    buffer_load_dwordx4 v[136:139], v249, s[28:31], s99 offen offset:0 nt
    s_waitcnt vmcnt(9)
    buffer_load_dwordx4 v[140:143], v249, s[28:31], s99 offen offset:1024 nt
    s_waitcnt vmcnt(9)
    buffer_load_dwordx4 v[144:147], v249, s[28:31], s99 offen offset:2048 nt
    s_waitcnt vmcnt(9)
    buffer_load_dwordx4 v[148:151], v249, s[28:31], s99 offen offset:3072 nt
    v_and_b32 v8, 7, v1
    v_lshlrev_b32 v8, 5, v8
    buffer_load_dword v248, v8, s[72:75], 0 offen sc1
    s_cmp_ge_u32 s14, 3
    s_cbranch_scc1 L_ql_skip
    v_lshlrev_b32 v8, 2, v0
    s_mul_i32 s40, s17, 24576
    s_mul_i32 s41, s15, 768
    s_add_u32 s40, s40, s41
    s_add_u32 s40, s40, 1048576

    buffer_load_dword v16, v8, s[36:39], s40 offen sc1
    s_add_u32 s40, s40, 49152
    buffer_load_dword v17, v8, s[36:39], s40 offen sc1
    s_add_u32 s40, s40, 49152
    buffer_load_dword v18, v8, s[36:39], s40 offen sc1
    s_add_u32 s40, s40, 49152
    buffer_load_dword v19, v8, s[36:39], s40 offen sc1
    s_add_u32 s40, s40, 49152
    buffer_load_dword v20, v8, s[36:39], s40 offen sc1
    s_add_u32 s40, s40, 49152
    buffer_load_dword v21, v8, s[36:39], s40 offen sc1
    s_add_u32 s40, s40, 49152
    buffer_load_dword v22, v8, s[36:39], s40 offen sc1
    s_add_u32 s40, s40, 49152
    buffer_load_dword v23, v8, s[36:39], s40 offen sc1
L_ql_skip:
    s_add_u32 s99, s43, 4096
    s_waitcnt vmcnt(9)
    buffer_load_dwordx4 v[152:155], v249, s[28:31], s99 offen offset:0 nt
    s_waitcnt vmcnt(9)
    buffer_load_dwordx4 v[156:159], v249, s[28:31], s99 offen offset:1024 nt
    s_waitcnt vmcnt(9)
    buffer_load_dwordx4 v[160:163], v249, s[28:31], s99 offen offset:2048 nt
    s_waitcnt vmcnt(9)
    buffer_load_dwordx4 v[164:167], v249, s[28:31], s99 offen offset:3072 nt
    s_add_u32 s99, s43, 8192
    s_waitcnt vmcnt(9)
    buffer_load_dwordx4 v[168:171], v249, s[28:31], s99 offen offset:0 nt
    s_waitcnt vmcnt(9)
    buffer_load_dwordx4 v[172:175], v249, s[28:31], s99 offen offset:1024 nt
    s_waitcnt vmcnt(9)
    buffer_load_dwordx4 v[176:179], v249, s[28:31], s99 offen offset:2048 nt
    s_waitcnt vmcnt(9)
    buffer_load_dwordx4 v[180:183], v249, s[28:31], s99 offen offset:3072 nt
    s_waitcnt vmcnt(8)
    s_mov_b32 s47, 0

L_chk:
    s_nop 1
    v_add_u32_dpp v9, v248, v248 quad_perm:[1,0,3,2] row_mask:0xf bank_mask:0xf
    s_nop 1
    v_add_u32_dpp v10, v9, v9 quad_perm:[2,3,0,1] row_mask:0xf bank_mask:0xf
    s_nop 1
    v_add_u32_dpp v9, v10, v10 row_half_mirror row_mask:0xf bank_mask:0xf
    s_nop 1
    v_readfirstlane_b32 s41, v9
    s_nop 3
    s_cmp_ge_u32 s41, 256
    s_cbranch_scc1 L_chk_done
    s_add_u32 s47, s47, 1
    s_cmp_ge_u32 s47, 100000
    s_cbranch_scc1 L_chk_done
    s_sleep 2
    v_and_b32 v8, 7, v1
    v_lshlrev_b32 v8, 5, v8
    buffer_load_dword v248, v8, s[72:75], 0 offen sc1
    s_waitcnt vmcnt(0)
    s_branch L_chk

L_chk_done:
    s_cmp_ge_u32 s14, 3
    s_cbranch_scc1 L_q_skip

    v_max_u32 v9, v16, v17
    v_max_u32 v9, v9, v18
    v_max_u32 v9, v9, v19
    v_max_u32 v9, v9, v20
    v_max_u32 v9, v9, v21
    v_max_u32 v9, v9, v22
    v_max_u32 v9, v9, v23
    v_cmp_eq_u32 vcc, -1, v9
    s_nop 3
    s_cmp_eq_u64 vcc, 0
    s_cbranch_scc1 L_q_ok

    s_mov_b32 s47, 0
L_pollq:
    v_lshlrev_b32 v8, 2, v0
    s_mul_i32 s40, s17, 24576
    s_mul_i32 s41, s15, 768
    s_add_u32 s40, s40, s41
    s_add_u32 s40, s40, 1048576

    buffer_load_dword v16, v8, s[36:39], s40 offen sc1
    s_add_u32 s40, s40, 49152
    buffer_load_dword v17, v8, s[36:39], s40 offen sc1
    s_add_u32 s40, s40, 49152
    buffer_load_dword v18, v8, s[36:39], s40 offen sc1
    s_add_u32 s40, s40, 49152
    buffer_load_dword v19, v8, s[36:39], s40 offen sc1
    s_add_u32 s40, s40, 49152
    buffer_load_dword v20, v8, s[36:39], s40 offen sc1
    s_add_u32 s40, s40, 49152
    buffer_load_dword v21, v8, s[36:39], s40 offen sc1
    s_add_u32 s40, s40, 49152
    buffer_load_dword v22, v8, s[36:39], s40 offen sc1
    s_add_u32 s40, s40, 49152
    buffer_load_dword v23, v8, s[36:39], s40 offen sc1
    s_waitcnt vmcnt(0)
    v_max_u32 v9, v16, v17
    v_max_u32 v9, v9, v18
    v_max_u32 v9, v9, v19
    v_max_u32 v9, v9, v20
    v_max_u32 v9, v9, v21
    v_max_u32 v9, v9, v22
    v_max_u32 v9, v9, v23
    v_cmp_eq_u32 vcc, -1, v9
    s_nop 3
    s_cmp_eq_u64 vcc, 0
    s_cbranch_scc1 L_pollq_done
    s_add_u32 s47, s47, 1
    s_cmp_ge_u32 s47, 100000
    s_cbranch_scc1 L_pollq_done
    s_sleep 2
    s_branch L_pollq

L_pollq_done:
L_q_ok:
    v_add_f32 v16, v16, v17
    v_add_f32 v16, v16, v18
    v_add_f32 v16, v16, v19
    v_add_f32 v16, v16, v20
    v_add_f32 v16, v16, v21
    v_add_f32 v16, v16, v22
    v_add_f32 v16, v16, v23
    v_cvt_pk_bf16_f32 v9, v16, v16
    v_lshlrev_b32 v8, 1, v0
    ds_write_b16 v8, v9 offset:0

L_q_skip:
    s_add_u32 s99, s43, 12288
    buffer_load_dwordx4 v[184:187], v249, s[28:31], s99 offen offset:0 nt
    buffer_load_dwordx4 v[188:191], v249, s[28:31], s99 offen offset:1024 nt
    buffer_load_dwordx4 v[192:195], v249, s[28:31], s99 offen offset:2048 nt
    buffer_load_dwordx4 v[196:199], v249, s[28:31], s99 offen offset:3072 nt
    s_add_u32 s99, s43, 16384
    buffer_load_dwordx4 v[200:203], v249, s[28:31], s99 offen offset:0 nt
    buffer_load_dwordx4 v[204:207], v249, s[28:31], s99 offen offset:1024 nt
    buffer_load_dwordx4 v[208:211], v249, s[28:31], s99 offen offset:2048 nt
    buffer_load_dwordx4 v[212:215], v249, s[28:31], s99 offen offset:3072 nt
    s_add_u32 s99, s43, 20480
    buffer_load_dwordx4 v[216:219], v249, s[28:31], s99 offen offset:0 nt
    buffer_load_dwordx4 v[220:223], v249, s[28:31], s99 offen offset:1024 nt
    buffer_load_dwordx4 v[224:227], v249, s[28:31], s99 offen offset:2048 nt
    buffer_load_dwordx4 v[228:231], v249, s[28:31], s99 offen offset:3072 nt
    s_waitcnt lgkmcnt(0)
    s_barrier

    ds_read_b128 v[232:235], v2 offset:0
    ds_read_b128 v[236:239], v3 offset:0
    ds_read_b128 v[240:243], v4 offset:0
    s_mul_i32 s47, s14, 6144
    s_add_u32 s47, s47, 53248
    v_lshlrev_b32 v8, 2, v1
    v_add_u32 v8, s47, v8
    s_waitcnt lgkmcnt(0)

    v_dot2_f32_bf16 v10, v40, v232, 0
    v_dot2_f32_bf16 v10, v41, v233, v10
    v_dot2_f32_bf16 v10, v42, v234, v10
    v_dot2_f32_bf16 v10, v43, v235, v10
    s_nop 2
    ds_write_b32 v8, v10 offset:0

    v_dot2_f32_bf16 v11, v44, v236, 0
    v_dot2_f32_bf16 v11, v45, v237, v11
    v_dot2_f32_bf16 v11, v46, v238, v11
    v_dot2_f32_bf16 v11, v47, v239, v11
    s_nop 2
    ds_write_b32 v8, v11 offset:256

    v_dot2_f32_bf16 v12, v48, v240, 0
    v_dot2_f32_bf16 v12, v49, v241, v12
    v_dot2_f32_bf16 v12, v50, v242, v12
    v_dot2_f32_bf16 v12, v51, v243, v12
    s_nop 2
    ds_write_b32 v8, v12 offset:512

    v_dot2_f32_bf16 v13, v52, v232, 0
    v_dot2_f32_bf16 v13, v53, v233, v13
    v_dot2_f32_bf16 v13, v54, v234, v13
    v_dot2_f32_bf16 v13, v55, v235, v13
    s_nop 2
    ds_write_b32 v8, v13 offset:768

    v_dot2_f32_bf16 v10, v56, v236, 0
    v_dot2_f32_bf16 v10, v57, v237, v10
    v_dot2_f32_bf16 v10, v58, v238, v10
    v_dot2_f32_bf16 v10, v59, v239, v10
    s_nop 2
    ds_write_b32 v8, v10 offset:1024

    v_dot2_f32_bf16 v11, v60, v240, 0
    v_dot2_f32_bf16 v11, v61, v241, v11
    v_dot2_f32_bf16 v11, v62, v242, v11
    v_dot2_f32_bf16 v11, v63, v243, v11
    s_nop 2
    ds_write_b32 v8, v11 offset:1280

    v_dot2_f32_bf16 v12, v64, v232, 0
    v_dot2_f32_bf16 v12, v65, v233, v12
    v_dot2_f32_bf16 v12, v66, v234, v12
    v_dot2_f32_bf16 v12, v67, v235, v12
    s_nop 2
    ds_write_b32 v8, v12 offset:1536

    v_dot2_f32_bf16 v13, v68, v236, 0
    v_dot2_f32_bf16 v13, v69, v237, v13
    v_dot2_f32_bf16 v13, v70, v238, v13
    v_dot2_f32_bf16 v13, v71, v239, v13
    s_nop 2
    ds_write_b32 v8, v13 offset:1792

    v_dot2_f32_bf16 v10, v72, v240, 0
    v_dot2_f32_bf16 v10, v73, v241, v10
    v_dot2_f32_bf16 v10, v74, v242, v10
    v_dot2_f32_bf16 v10, v75, v243, v10
    s_nop 2
    ds_write_b32 v8, v10 offset:2048

    v_dot2_f32_bf16 v11, v76, v232, 0
    v_dot2_f32_bf16 v11, v77, v233, v11
    v_dot2_f32_bf16 v11, v78, v234, v11
    v_dot2_f32_bf16 v11, v79, v235, v11
    s_nop 2
    ds_write_b32 v8, v11 offset:2304

    v_dot2_f32_bf16 v12, v80, v236, 0
    v_dot2_f32_bf16 v12, v81, v237, v12
    v_dot2_f32_bf16 v12, v82, v238, v12
    v_dot2_f32_bf16 v12, v83, v239, v12
    s_nop 2
    ds_write_b32 v8, v12 offset:2560

    v_dot2_f32_bf16 v13, v84, v240, 0
    v_dot2_f32_bf16 v13, v85, v241, v13
    v_dot2_f32_bf16 v13, v86, v242, v13
    v_dot2_f32_bf16 v13, v87, v243, v13
    s_nop 2
    ds_write_b32 v8, v13 offset:2816

    v_dot2_f32_bf16 v10, v88, v232, 0
    v_dot2_f32_bf16 v10, v89, v233, v10
    v_dot2_f32_bf16 v10, v90, v234, v10
    v_dot2_f32_bf16 v10, v91, v235, v10
    s_nop 2
    ds_write_b32 v8, v10 offset:3072

    v_dot2_f32_bf16 v11, v92, v236, 0
    v_dot2_f32_bf16 v11, v93, v237, v11
    v_dot2_f32_bf16 v11, v94, v238, v11
    v_dot2_f32_bf16 v11, v95, v239, v11
    s_nop 2
    ds_write_b32 v8, v11 offset:3328

    v_dot2_f32_bf16 v12, v96, v240, 0
    v_dot2_f32_bf16 v12, v97, v241, v12
    v_dot2_f32_bf16 v12, v98, v242, v12
    v_dot2_f32_bf16 v12, v99, v243, v12
    s_nop 2
    ds_write_b32 v8, v12 offset:3584

    v_dot2_f32_bf16 v13, v100, v232, 0
    v_dot2_f32_bf16 v13, v101, v233, v13
    v_dot2_f32_bf16 v13, v102, v234, v13
    v_dot2_f32_bf16 v13, v103, v235, v13
    s_nop 2
    ds_write_b32 v8, v13 offset:3840

    v_dot2_f32_bf16 v10, v104, v236, 0
    v_dot2_f32_bf16 v10, v105, v237, v10
    v_dot2_f32_bf16 v10, v106, v238, v10
    v_dot2_f32_bf16 v10, v107, v239, v10
    s_nop 2
    ds_write_b32 v8, v10 offset:4096

    v_dot2_f32_bf16 v11, v108, v240, 0
    v_dot2_f32_bf16 v11, v109, v241, v11
    v_dot2_f32_bf16 v11, v110, v242, v11
    v_dot2_f32_bf16 v11, v111, v243, v11
    s_nop 2
    ds_write_b32 v8, v11 offset:4352

    v_dot2_f32_bf16 v12, v112, v232, 0
    v_dot2_f32_bf16 v12, v113, v233, v12
    v_dot2_f32_bf16 v12, v114, v234, v12
    v_dot2_f32_bf16 v12, v115, v235, v12
    s_nop 2
    ds_write_b32 v8, v12 offset:4608

    v_dot2_f32_bf16 v13, v116, v236, 0
    v_dot2_f32_bf16 v13, v117, v237, v13
    v_dot2_f32_bf16 v13, v118, v238, v13
    v_dot2_f32_bf16 v13, v119, v239, v13
    s_nop 2
    ds_write_b32 v8, v13 offset:4864

    v_dot2_f32_bf16 v10, v120, v240, 0
    v_dot2_f32_bf16 v10, v121, v241, v10
    v_dot2_f32_bf16 v10, v122, v242, v10
    v_dot2_f32_bf16 v10, v123, v243, v10
    s_nop 2
    ds_write_b32 v8, v10 offset:5120

    v_dot2_f32_bf16 v11, v124, v232, 0
    v_dot2_f32_bf16 v11, v125, v233, v11
    v_dot2_f32_bf16 v11, v126, v234, v11
    v_dot2_f32_bf16 v11, v127, v235, v11
    s_nop 2
    ds_write_b32 v8, v11 offset:5376

    v_dot2_f32_bf16 v12, v128, v236, 0
    v_dot2_f32_bf16 v12, v129, v237, v12
    v_dot2_f32_bf16 v12, v130, v238, v12
    v_dot2_f32_bf16 v12, v131, v239, v12
    s_nop 2
    ds_write_b32 v8, v12 offset:5632

    v_dot2_f32_bf16 v13, v132, v240, 0
    v_dot2_f32_bf16 v13, v133, v241, v13
    v_dot2_f32_bf16 v13, v134, v242, v13
    v_dot2_f32_bf16 v13, v135, v243, v13
    s_nop 2
    ds_write_b32 v8, v13 offset:5888

    v_mul_u32_u24 v9, 96, v1
    v_add_u32 v9, s47, v9
    s_waitcnt lgkmcnt(0)

    ds_read_b128 v[40:43], v9 offset:0
    ds_read_b128 v[44:47], v9 offset:16
    ds_read_b128 v[48:51], v9 offset:32
    ds_read_b128 v[52:55], v9 offset:48
    ds_read_b128 v[56:59], v9 offset:64
    ds_read_b128 v[60:63], v9 offset:80
    s_waitcnt lgkmcnt(0)
    v_add_f32 v10, v40, v41
    v_add_f32 v10, v10, v42
    v_add_f32 v10, v10, v43
    v_add_f32 v10, v10, v44
    v_add_f32 v10, v10, v45
    v_add_f32 v10, v10, v46
    v_add_f32 v10, v10, v47
    v_add_f32 v10, v10, v48
    v_add_f32 v10, v10, v49
    v_add_f32 v10, v10, v50
    v_add_f32 v10, v10, v51
    v_add_f32 v10, v10, v52
    v_add_f32 v10, v10, v53
    v_add_f32 v10, v10, v54
    v_add_f32 v10, v10, v55
    v_add_f32 v10, v10, v56
    v_add_f32 v10, v10, v57
    v_add_f32 v10, v10, v58
    v_add_f32 v10, v10, v59
    v_add_f32 v10, v10, v60
    v_add_f32 v10, v10, v61
    v_add_f32 v10, v10, v62
    v_add_f32 v10, v10, v63
    s_cmp_ge_u32 s16, 20
    s_cbranch_scc1 L_pf_done
    v_and_b32 v8, 3, v0
    v_lshrrev_b32 v9, 2, v0
    v_mul_u32_u24 v9, 1280, v9
    v_lshlrev_b32 v8, 4, v8
    v_add_u32 v9, v9, v8
    s_mul_i32 s40, s19, 983040
    s_lshl_b32 s41, s16, 6
    s_add_u32 s40, s40, s41

    buffer_load_dwordx4 v[40:43], v9, s[52:55], s40 offen nt
    s_add_u32 s40, s40, 163840
    buffer_load_dwordx4 v[44:47], v9, s[52:55], s40 offen nt
    s_add_u32 s40, s40, 163840
    buffer_load_dwordx4 v[48:51], v9, s[52:55], s40 offen nt
    s_add_u32 s40, s40, 163840
    buffer_load_dwordx4 v[52:55], v9, s[52:55], s40 offen nt
    s_add_u32 s40, s40, 163840
    buffer_load_dwordx4 v[56:59], v9, s[52:55], s40 offen nt
    s_add_u32 s40, s40, 163840
    buffer_load_dwordx4 v[60:63], v9, s[52:55], s40 offen nt
L_pf_done:
    v_cvt_pk_bf16_f32 v10, v10, v10
    v_lshlrev_b32 v10, 16, v10

    v_mul_f32 v10, 1033096506, v10
    v_cvt_pk_bf16_f32 v10, v10, v10
    v_lshlrev_b32 v10, 16, v10

    v_mov_b32 v12, v10
    s_nop 1
    v_max_f32_dpp v13, v12, v12 quad_perm:[1,0,3,2] row_mask:0xf bank_mask:0xf
    s_nop 1
    v_max_f32_dpp v12, v13, v13 quad_perm:[2,3,0,1] row_mask:0xf bank_mask:0xf
    s_nop 1
    v_max_f32_dpp v13, v12, v12 row_half_mirror row_mask:0xf bank_mask:0xf
    s_nop 1
    v_max_f32_dpp v12, v13, v13 row_mirror row_mask:0xf bank_mask:0xf
    s_nop 1
    v_readlane_b32 s44, v12, 0
    v_readlane_b32 s45, v12, 16
    v_readlane_b32 s46, v12, 32
    v_readlane_b32 s47, v12, 48
    s_nop 1
    v_mov_b32 v12, s44
    v_max_f32 v12, s45, v12
    v_max_f32 v12, s46, v12
    v_max_f32 v12, s47, v12

    v_sub_f32 v10, v10, v12
    v_mul_f32 v10, 1069066811, v10
    v_exp_f32 v10, v10
    s_nop 0
    v_mov_b32 v13, v10

    s_nop 1
    v_add_f32_dpp v11, v13, v13 quad_perm:[1,0,3,2] row_mask:0xf bank_mask:0xf
    s_nop 1
    v_add_f32_dpp v13, v11, v11 quad_perm:[2,3,0,1] row_mask:0xf bank_mask:0xf
    s_nop 1
    v_add_f32_dpp v11, v13, v13 row_half_mirror row_mask:0xf bank_mask:0xf
    s_nop 1
    v_add_f32_dpp v13, v11, v11 row_mirror row_mask:0xf bank_mask:0xf
    s_nop 1
    v_readlane_b32 s44, v13, 0
    v_readlane_b32 s45, v13, 16
    v_readlane_b32 s46, v13, 32
    v_readlane_b32 s47, v13, 48
    s_nop 1
    v_mov_b32 v13, s44
    v_add_f32 v13, s45, v13
    v_add_f32 v13, s46, v13
    v_add_f32 v13, s47, v13

    s_lshl_b32 s47, s14, 8
    s_add_u32 s47, s47, 1024
    v_lshlrev_b32 v8, 2, v1
    v_add_u32 v8, s47, v8
    ds_write_b32 v8, v10
    s_lshl_b32 s40, s14, 3
    v_mov_b32 v8, s40
    ds_write_b64 v8, v[12:13] offset:512
    v_add_u32 v8, s47, v5
    v_add_u32 v9, s47, v6
    v_add_u32 v10, s47, v7
    s_waitcnt lgkmcnt(0)

    v_mov_b32 v16, 0
    v_mov_b32 v17, 0
    v_mov_b32 v18, 0
    v_mov_b32 v19, 0
    v_mov_b32 v20, 0
    v_mov_b32 v21, 0
    v_mov_b32 v22, 0
    v_mov_b32 v23, 0
    v_mov_b32 v24, 0
    v_mov_b32 v25, 0
    v_mov_b32 v26, 0
    v_mov_b32 v27, 0
    v_mov_b32 v28, 0
    v_mov_b32 v29, 0
    v_mov_b32 v30, 0
    v_mov_b32 v31, 0
    v_mov_b32 v32, 0
    v_mov_b32 v33, 0
    v_mov_b32 v34, 0
    v_mov_b32 v35, 0
    v_mov_b32 v36, 0
    v_mov_b32 v37, 0
    v_mov_b32 v38, 0
    v_mov_b32 v39, 0
    ds_read_b32 v11, v8 offset:0
    ds_read_b32 v12, v9 offset:0
    ds_read_b32 v13, v10 offset:0

    s_waitcnt vmcnt(23) lgkmcnt(2)
    v_lshlrev_b32 v14, 16, v136
    v_and_b32 v15, 0xffff0000, v136
    v_fmac_f32 v16, v11, v14
    v_fmac_f32 v17, v11, v15

    v_lshlrev_b32 v14, 16, v137
    v_and_b32 v15, 0xffff0000, v137
    v_fmac_f32 v18, v11, v14
    v_fmac_f32 v19, v11, v15

    v_lshlrev_b32 v14, 16, v138
    v_and_b32 v15, 0xffff0000, v138
    v_fmac_f32 v20, v11, v14
    v_fmac_f32 v21, v11, v15

    v_lshlrev_b32 v14, 16, v139
    v_and_b32 v15, 0xffff0000, v139
    v_fmac_f32 v22, v11, v14
    v_fmac_f32 v23, v11, v15

    s_waitcnt vmcnt(22) lgkmcnt(1)
    v_lshlrev_b32 v14, 16, v140
    v_and_b32 v15, 0xffff0000, v140
    v_fmac_f32 v24, v12, v14
    v_fmac_f32 v25, v12, v15

    v_lshlrev_b32 v14, 16, v141
    v_and_b32 v15, 0xffff0000, v141
    v_fmac_f32 v26, v12, v14
    v_fmac_f32 v27, v12, v15

    v_lshlrev_b32 v14, 16, v142
    v_and_b32 v15, 0xffff0000, v142
    v_fmac_f32 v28, v12, v14
    v_fmac_f32 v29, v12, v15

    v_lshlrev_b32 v14, 16, v143
    v_and_b32 v15, 0xffff0000, v143
    v_fmac_f32 v30, v12, v14
    v_fmac_f32 v31, v12, v15

    s_waitcnt vmcnt(21) lgkmcnt(0)
    v_lshlrev_b32 v14, 16, v144
    v_and_b32 v15, 0xffff0000, v144
    v_fmac_f32 v32, v13, v14
    v_fmac_f32 v33, v13, v15

    v_lshlrev_b32 v14, 16, v145
    v_and_b32 v15, 0xffff0000, v145
    v_fmac_f32 v34, v13, v14
    v_fmac_f32 v35, v13, v15

    v_lshlrev_b32 v14, 16, v146
    v_and_b32 v15, 0xffff0000, v146
    v_fmac_f32 v36, v13, v14
    v_fmac_f32 v37, v13, v15

    v_lshlrev_b32 v14, 16, v147
    v_and_b32 v15, 0xffff0000, v147
    v_fmac_f32 v38, v13, v14
    v_fmac_f32 v39, v13, v15

    ds_read_b32 v11, v8 offset:32
    ds_read_b32 v12, v9 offset:32
    ds_read_b32 v13, v10 offset:32

    s_waitcnt vmcnt(20) lgkmcnt(2)
    v_lshlrev_b32 v14, 16, v148
    v_and_b32 v15, 0xffff0000, v148
    v_fmac_f32 v16, v11, v14
    v_fmac_f32 v17, v11, v15

    v_lshlrev_b32 v14, 16, v149
    v_and_b32 v15, 0xffff0000, v149
    v_fmac_f32 v18, v11, v14
    v_fmac_f32 v19, v11, v15

    v_lshlrev_b32 v14, 16, v150
    v_and_b32 v15, 0xffff0000, v150
    v_fmac_f32 v20, v11, v14
    v_fmac_f32 v21, v11, v15

    v_lshlrev_b32 v14, 16, v151
    v_and_b32 v15, 0xffff0000, v151
    v_fmac_f32 v22, v11, v14
    v_fmac_f32 v23, v11, v15

    s_waitcnt vmcnt(19) lgkmcnt(1)
    v_lshlrev_b32 v14, 16, v152
    v_and_b32 v15, 0xffff0000, v152
    v_fmac_f32 v24, v12, v14
    v_fmac_f32 v25, v12, v15

    v_lshlrev_b32 v14, 16, v153
    v_and_b32 v15, 0xffff0000, v153
    v_fmac_f32 v26, v12, v14
    v_fmac_f32 v27, v12, v15

    v_lshlrev_b32 v14, 16, v154
    v_and_b32 v15, 0xffff0000, v154
    v_fmac_f32 v28, v12, v14
    v_fmac_f32 v29, v12, v15

    v_lshlrev_b32 v14, 16, v155
    v_and_b32 v15, 0xffff0000, v155
    v_fmac_f32 v30, v12, v14
    v_fmac_f32 v31, v12, v15

    s_waitcnt vmcnt(18) lgkmcnt(0)
    v_lshlrev_b32 v14, 16, v156
    v_and_b32 v15, 0xffff0000, v156
    v_fmac_f32 v32, v13, v14
    v_fmac_f32 v33, v13, v15

    v_lshlrev_b32 v14, 16, v157
    v_and_b32 v15, 0xffff0000, v157
    v_fmac_f32 v34, v13, v14
    v_fmac_f32 v35, v13, v15

    v_lshlrev_b32 v14, 16, v158
    v_and_b32 v15, 0xffff0000, v158
    v_fmac_f32 v36, v13, v14
    v_fmac_f32 v37, v13, v15

    v_lshlrev_b32 v14, 16, v159
    v_and_b32 v15, 0xffff0000, v159
    v_fmac_f32 v38, v13, v14
    v_fmac_f32 v39, v13, v15

    ds_read_b32 v11, v8 offset:64
    ds_read_b32 v12, v9 offset:64
    ds_read_b32 v13, v10 offset:64

    s_waitcnt vmcnt(17) lgkmcnt(2)
    v_lshlrev_b32 v14, 16, v160
    v_and_b32 v15, 0xffff0000, v160
    v_fmac_f32 v16, v11, v14
    v_fmac_f32 v17, v11, v15

    v_lshlrev_b32 v14, 16, v161
    v_and_b32 v15, 0xffff0000, v161
    v_fmac_f32 v18, v11, v14
    v_fmac_f32 v19, v11, v15

    v_lshlrev_b32 v14, 16, v162
    v_and_b32 v15, 0xffff0000, v162
    v_fmac_f32 v20, v11, v14
    v_fmac_f32 v21, v11, v15

    v_lshlrev_b32 v14, 16, v163
    v_and_b32 v15, 0xffff0000, v163
    v_fmac_f32 v22, v11, v14
    v_fmac_f32 v23, v11, v15

    s_waitcnt vmcnt(16) lgkmcnt(1)
    v_lshlrev_b32 v14, 16, v164
    v_and_b32 v15, 0xffff0000, v164
    v_fmac_f32 v24, v12, v14
    v_fmac_f32 v25, v12, v15

    v_lshlrev_b32 v14, 16, v165
    v_and_b32 v15, 0xffff0000, v165
    v_fmac_f32 v26, v12, v14
    v_fmac_f32 v27, v12, v15

    v_lshlrev_b32 v14, 16, v166
    v_and_b32 v15, 0xffff0000, v166
    v_fmac_f32 v28, v12, v14
    v_fmac_f32 v29, v12, v15

    v_lshlrev_b32 v14, 16, v167
    v_and_b32 v15, 0xffff0000, v167
    v_fmac_f32 v30, v12, v14
    v_fmac_f32 v31, v12, v15

    s_waitcnt vmcnt(15) lgkmcnt(0)
    v_lshlrev_b32 v14, 16, v168
    v_and_b32 v15, 0xffff0000, v168
    v_fmac_f32 v32, v13, v14
    v_fmac_f32 v33, v13, v15

    v_lshlrev_b32 v14, 16, v169
    v_and_b32 v15, 0xffff0000, v169
    v_fmac_f32 v34, v13, v14
    v_fmac_f32 v35, v13, v15

    v_lshlrev_b32 v14, 16, v170
    v_and_b32 v15, 0xffff0000, v170
    v_fmac_f32 v36, v13, v14
    v_fmac_f32 v37, v13, v15

    v_lshlrev_b32 v14, 16, v171
    v_and_b32 v15, 0xffff0000, v171
    v_fmac_f32 v38, v13, v14
    v_fmac_f32 v39, v13, v15

    ds_read_b32 v11, v8 offset:96
    ds_read_b32 v12, v9 offset:96
    ds_read_b32 v13, v10 offset:96

    s_waitcnt vmcnt(14) lgkmcnt(2)
    v_lshlrev_b32 v14, 16, v172
    v_and_b32 v15, 0xffff0000, v172
    v_fmac_f32 v16, v11, v14
    v_fmac_f32 v17, v11, v15

    v_lshlrev_b32 v14, 16, v173
    v_and_b32 v15, 0xffff0000, v173
    v_fmac_f32 v18, v11, v14
    v_fmac_f32 v19, v11, v15

    v_lshlrev_b32 v14, 16, v174
    v_and_b32 v15, 0xffff0000, v174
    v_fmac_f32 v20, v11, v14
    v_fmac_f32 v21, v11, v15

    v_lshlrev_b32 v14, 16, v175
    v_and_b32 v15, 0xffff0000, v175
    v_fmac_f32 v22, v11, v14
    v_fmac_f32 v23, v11, v15

    s_waitcnt vmcnt(13) lgkmcnt(1)
    v_lshlrev_b32 v14, 16, v176
    v_and_b32 v15, 0xffff0000, v176
    v_fmac_f32 v24, v12, v14
    v_fmac_f32 v25, v12, v15

    v_lshlrev_b32 v14, 16, v177
    v_and_b32 v15, 0xffff0000, v177
    v_fmac_f32 v26, v12, v14
    v_fmac_f32 v27, v12, v15

    v_lshlrev_b32 v14, 16, v178
    v_and_b32 v15, 0xffff0000, v178
    v_fmac_f32 v28, v12, v14
    v_fmac_f32 v29, v12, v15

    v_lshlrev_b32 v14, 16, v179
    v_and_b32 v15, 0xffff0000, v179
    v_fmac_f32 v30, v12, v14
    v_fmac_f32 v31, v12, v15

    s_waitcnt vmcnt(12) lgkmcnt(0)
    v_lshlrev_b32 v14, 16, v180
    v_and_b32 v15, 0xffff0000, v180
    v_fmac_f32 v32, v13, v14
    v_fmac_f32 v33, v13, v15

    v_lshlrev_b32 v14, 16, v181
    v_and_b32 v15, 0xffff0000, v181
    v_fmac_f32 v34, v13, v14
    v_fmac_f32 v35, v13, v15

    v_lshlrev_b32 v14, 16, v182
    v_and_b32 v15, 0xffff0000, v182
    v_fmac_f32 v36, v13, v14
    v_fmac_f32 v37, v13, v15

    v_lshlrev_b32 v14, 16, v183
    v_and_b32 v15, 0xffff0000, v183
    v_fmac_f32 v38, v13, v14
    v_fmac_f32 v39, v13, v15

    ds_read_b32 v11, v8 offset:128
    ds_read_b32 v12, v9 offset:128
    ds_read_b32 v13, v10 offset:128

    s_waitcnt vmcnt(11) lgkmcnt(2)
    v_lshlrev_b32 v14, 16, v184
    v_and_b32 v15, 0xffff0000, v184
    v_fmac_f32 v16, v11, v14
    v_fmac_f32 v17, v11, v15

    v_lshlrev_b32 v14, 16, v185
    v_and_b32 v15, 0xffff0000, v185
    v_fmac_f32 v18, v11, v14
    v_fmac_f32 v19, v11, v15

    v_lshlrev_b32 v14, 16, v186
    v_and_b32 v15, 0xffff0000, v186
    v_fmac_f32 v20, v11, v14
    v_fmac_f32 v21, v11, v15

    v_lshlrev_b32 v14, 16, v187
    v_and_b32 v15, 0xffff0000, v187
    v_fmac_f32 v22, v11, v14
    v_fmac_f32 v23, v11, v15

    s_waitcnt vmcnt(10) lgkmcnt(1)
    v_lshlrev_b32 v14, 16, v188
    v_and_b32 v15, 0xffff0000, v188
    v_fmac_f32 v24, v12, v14
    v_fmac_f32 v25, v12, v15

    v_lshlrev_b32 v14, 16, v189
    v_and_b32 v15, 0xffff0000, v189
    v_fmac_f32 v26, v12, v14
    v_fmac_f32 v27, v12, v15

    v_lshlrev_b32 v14, 16, v190
    v_and_b32 v15, 0xffff0000, v190
    v_fmac_f32 v28, v12, v14
    v_fmac_f32 v29, v12, v15

    v_lshlrev_b32 v14, 16, v191
    v_and_b32 v15, 0xffff0000, v191
    v_fmac_f32 v30, v12, v14
    v_fmac_f32 v31, v12, v15

    s_waitcnt vmcnt(9) lgkmcnt(0)
    v_lshlrev_b32 v14, 16, v192
    v_and_b32 v15, 0xffff0000, v192
    v_fmac_f32 v32, v13, v14
    v_fmac_f32 v33, v13, v15

    v_lshlrev_b32 v14, 16, v193
    v_and_b32 v15, 0xffff0000, v193
    v_fmac_f32 v34, v13, v14
    v_fmac_f32 v35, v13, v15

    v_lshlrev_b32 v14, 16, v194
    v_and_b32 v15, 0xffff0000, v194
    v_fmac_f32 v36, v13, v14
    v_fmac_f32 v37, v13, v15

    v_lshlrev_b32 v14, 16, v195
    v_and_b32 v15, 0xffff0000, v195
    v_fmac_f32 v38, v13, v14
    v_fmac_f32 v39, v13, v15

    ds_read_b32 v11, v8 offset:160
    ds_read_b32 v12, v9 offset:160
    ds_read_b32 v13, v10 offset:160

    s_waitcnt vmcnt(8) lgkmcnt(2)
    v_lshlrev_b32 v14, 16, v196
    v_and_b32 v15, 0xffff0000, v196
    v_fmac_f32 v16, v11, v14
    v_fmac_f32 v17, v11, v15

    v_lshlrev_b32 v14, 16, v197
    v_and_b32 v15, 0xffff0000, v197
    v_fmac_f32 v18, v11, v14
    v_fmac_f32 v19, v11, v15

    v_lshlrev_b32 v14, 16, v198
    v_and_b32 v15, 0xffff0000, v198
    v_fmac_f32 v20, v11, v14
    v_fmac_f32 v21, v11, v15

    v_lshlrev_b32 v14, 16, v199
    v_and_b32 v15, 0xffff0000, v199
    v_fmac_f32 v22, v11, v14
    v_fmac_f32 v23, v11, v15

    s_waitcnt vmcnt(7) lgkmcnt(1)
    v_lshlrev_b32 v14, 16, v200
    v_and_b32 v15, 0xffff0000, v200
    v_fmac_f32 v24, v12, v14
    v_fmac_f32 v25, v12, v15

    v_lshlrev_b32 v14, 16, v201
    v_and_b32 v15, 0xffff0000, v201
    v_fmac_f32 v26, v12, v14
    v_fmac_f32 v27, v12, v15

    v_lshlrev_b32 v14, 16, v202
    v_and_b32 v15, 0xffff0000, v202
    v_fmac_f32 v28, v12, v14
    v_fmac_f32 v29, v12, v15

    v_lshlrev_b32 v14, 16, v203
    v_and_b32 v15, 0xffff0000, v203
    v_fmac_f32 v30, v12, v14
    v_fmac_f32 v31, v12, v15

    s_waitcnt vmcnt(6) lgkmcnt(0)
    v_lshlrev_b32 v14, 16, v204
    v_and_b32 v15, 0xffff0000, v204
    v_fmac_f32 v32, v13, v14
    v_fmac_f32 v33, v13, v15

    v_lshlrev_b32 v14, 16, v205
    v_and_b32 v15, 0xffff0000, v205
    v_fmac_f32 v34, v13, v14
    v_fmac_f32 v35, v13, v15

    v_lshlrev_b32 v14, 16, v206
    v_and_b32 v15, 0xffff0000, v206
    v_fmac_f32 v36, v13, v14
    v_fmac_f32 v37, v13, v15

    v_lshlrev_b32 v14, 16, v207
    v_and_b32 v15, 0xffff0000, v207
    v_fmac_f32 v38, v13, v14
    v_fmac_f32 v39, v13, v15

    ds_read_b32 v11, v8 offset:192
    ds_read_b32 v12, v9 offset:192
    ds_read_b32 v13, v10 offset:192

    s_waitcnt vmcnt(5) lgkmcnt(2)
    v_lshlrev_b32 v14, 16, v208
    v_and_b32 v15, 0xffff0000, v208
    v_fmac_f32 v16, v11, v14
    v_fmac_f32 v17, v11, v15

    v_lshlrev_b32 v14, 16, v209
    v_and_b32 v15, 0xffff0000, v209
    v_fmac_f32 v18, v11, v14
    v_fmac_f32 v19, v11, v15

    v_lshlrev_b32 v14, 16, v210
    v_and_b32 v15, 0xffff0000, v210
    v_fmac_f32 v20, v11, v14
    v_fmac_f32 v21, v11, v15

    v_lshlrev_b32 v14, 16, v211
    v_and_b32 v15, 0xffff0000, v211
    v_fmac_f32 v22, v11, v14
    v_fmac_f32 v23, v11, v15

    s_waitcnt vmcnt(4) lgkmcnt(1)
    v_lshlrev_b32 v14, 16, v212
    v_and_b32 v15, 0xffff0000, v212
    v_fmac_f32 v24, v12, v14
    v_fmac_f32 v25, v12, v15

    v_lshlrev_b32 v14, 16, v213
    v_and_b32 v15, 0xffff0000, v213
    v_fmac_f32 v26, v12, v14
    v_fmac_f32 v27, v12, v15

    v_lshlrev_b32 v14, 16, v214
    v_and_b32 v15, 0xffff0000, v214
    v_fmac_f32 v28, v12, v14
    v_fmac_f32 v29, v12, v15

    v_lshlrev_b32 v14, 16, v215
    v_and_b32 v15, 0xffff0000, v215
    v_fmac_f32 v30, v12, v14
    v_fmac_f32 v31, v12, v15

    s_waitcnt vmcnt(3) lgkmcnt(0)
    v_lshlrev_b32 v14, 16, v216
    v_and_b32 v15, 0xffff0000, v216
    v_fmac_f32 v32, v13, v14
    v_fmac_f32 v33, v13, v15

    v_lshlrev_b32 v14, 16, v217
    v_and_b32 v15, 0xffff0000, v217
    v_fmac_f32 v34, v13, v14
    v_fmac_f32 v35, v13, v15

    v_lshlrev_b32 v14, 16, v218
    v_and_b32 v15, 0xffff0000, v218
    v_fmac_f32 v36, v13, v14
    v_fmac_f32 v37, v13, v15

    v_lshlrev_b32 v14, 16, v219
    v_and_b32 v15, 0xffff0000, v219
    v_fmac_f32 v38, v13, v14
    v_fmac_f32 v39, v13, v15

    ds_read_b32 v11, v8 offset:224
    ds_read_b32 v12, v9 offset:224
    ds_read_b32 v13, v10 offset:224

    s_waitcnt vmcnt(2) lgkmcnt(2)
    v_lshlrev_b32 v14, 16, v220
    v_and_b32 v15, 0xffff0000, v220
    v_fmac_f32 v16, v11, v14
    v_fmac_f32 v17, v11, v15

    v_lshlrev_b32 v14, 16, v221
    v_and_b32 v15, 0xffff0000, v221
    v_fmac_f32 v18, v11, v14
    v_fmac_f32 v19, v11, v15

    v_lshlrev_b32 v14, 16, v222
    v_and_b32 v15, 0xffff0000, v222
    v_fmac_f32 v20, v11, v14
    v_fmac_f32 v21, v11, v15

    v_lshlrev_b32 v14, 16, v223
    v_and_b32 v15, 0xffff0000, v223
    v_fmac_f32 v22, v11, v14
    v_fmac_f32 v23, v11, v15

    s_waitcnt vmcnt(1) lgkmcnt(1)
    v_lshlrev_b32 v14, 16, v224
    v_and_b32 v15, 0xffff0000, v224
    v_fmac_f32 v24, v12, v14
    v_fmac_f32 v25, v12, v15

    v_lshlrev_b32 v14, 16, v225
    v_and_b32 v15, 0xffff0000, v225
    v_fmac_f32 v26, v12, v14
    v_fmac_f32 v27, v12, v15

    v_lshlrev_b32 v14, 16, v226
    v_and_b32 v15, 0xffff0000, v226
    v_fmac_f32 v28, v12, v14
    v_fmac_f32 v29, v12, v15

    v_lshlrev_b32 v14, 16, v227
    v_and_b32 v15, 0xffff0000, v227
    v_fmac_f32 v30, v12, v14
    v_fmac_f32 v31, v12, v15

    s_waitcnt vmcnt(0) lgkmcnt(0)
    v_lshlrev_b32 v14, 16, v228
    v_and_b32 v15, 0xffff0000, v228
    v_fmac_f32 v32, v13, v14
    v_fmac_f32 v33, v13, v15

    v_lshlrev_b32 v14, 16, v229
    v_and_b32 v15, 0xffff0000, v229
    v_fmac_f32 v34, v13, v14
    v_fmac_f32 v35, v13, v15

    v_lshlrev_b32 v14, 16, v230
    v_and_b32 v15, 0xffff0000, v230
    v_fmac_f32 v36, v13, v14
    v_fmac_f32 v37, v13, v15

    v_lshlrev_b32 v14, 16, v231
    v_and_b32 v15, 0xffff0000, v231
    v_fmac_f32 v38, v13, v14
    v_fmac_f32 v39, v13, v15

    s_mul_i32 s47, s14, 6144
    v_lshlrev_b32 v8, 5, v1
    v_add_u32 v8, s47, v8

    ds_write_b128 v8, v[16:19] offset:4096
    ds_write_b128 v8, v[20:23] offset:4112

    ds_write_b128 v8, v[24:27] offset:6144
    ds_write_b128 v8, v[28:31] offset:6160

    ds_write_b128 v8, v[32:35] offset:8192
    ds_write_b128 v8, v[36:39] offset:8208

    s_waitcnt lgkmcnt(0)
    s_barrier
    s_cmp_ge_u32 s14, 3
    s_cbranch_scc1 L_att_fin
    v_mov_b32 v8, 0

    ds_read_b128 v[80:83], v8 offset:512
    ds_read_b128 v[84:87], v8 offset:528
    ds_read_b128 v[88:91], v8 offset:544
    ds_read_b128 v[92:95], v8 offset:560
    s_waitcnt lgkmcnt(0)
    v_max_f32 v9, v80, v82
    v_max_f32 v9, v9, v84
    v_max_f32 v9, v9, v86
    v_max_f32 v9, v9, v88
    v_max_f32 v9, v9, v90
    v_max_f32 v9, v9, v92
    v_max_f32 v9, v9, v94
    v_sub_f32 v96, v80, v9
    v_mul_f32 v96, 1069066811, v96
    v_exp_f32 v96, v96

    v_sub_f32 v97, v82, v9
    v_mul_f32 v97, 1069066811, v97
    v_exp_f32 v97, v97

    v_sub_f32 v98, v84, v9
    v_mul_f32 v98, 1069066811, v98
    v_exp_f32 v98, v98

    v_sub_f32 v99, v86, v9
    v_mul_f32 v99, 1069066811, v99
    v_exp_f32 v99, v99

    v_sub_f32 v100, v88, v9
    v_mul_f32 v100, 1069066811, v100
    v_exp_f32 v100, v100

    v_sub_f32 v101, v90, v9
    v_mul_f32 v101, 1069066811, v101
    v_exp_f32 v101, v101

    v_sub_f32 v102, v92, v9
    v_mul_f32 v102, 1069066811, v102
    v_exp_f32 v102, v102

    v_sub_f32 v103, v94, v9
    v_mul_f32 v103, 1069066811, v103
    v_exp_f32 v103, v103

    s_nop 0
    v_mul_f32 v10, v96, v81
    v_fmac_f32 v10, v97, v83
    v_fmac_f32 v10, v98, v85
    v_fmac_f32 v10, v99, v87
    v_fmac_f32 v10, v100, v89
    v_fmac_f32 v10, v101, v91
    v_fmac_f32 v10, v102, v93
    v_fmac_f32 v10, v103, v95
    v_lshlrev_b32 v8, 2, v0
    v_mov_b32 v11, 0
    ds_read_b32 v104, v8 offset:4096
    ds_read_b32 v105, v8 offset:4864
    ds_read_b32 v106, v8 offset:5632
    ds_read_b32 v107, v8 offset:6400
    ds_read_b32 v108, v8 offset:7168
    ds_read_b32 v109, v8 offset:7936
    ds_read_b32 v110, v8 offset:8704
    ds_read_b32 v111, v8 offset:9472
    ds_read_b32 v112, v8 offset:10240
    ds_read_b32 v113, v8 offset:11008
    ds_read_b32 v114, v8 offset:11776
    ds_read_b32 v115, v8 offset:12544
    ds_read_b32 v116, v8 offset:13312
    ds_read_b32 v117, v8 offset:14080
    ds_read_b32 v118, v8 offset:14848
    ds_read_b32 v119, v8 offset:15616
    ds_read_b32 v120, v8 offset:16384
    ds_read_b32 v121, v8 offset:17152
    ds_read_b32 v122, v8 offset:17920
    ds_read_b32 v123, v8 offset:18688
    ds_read_b32 v124, v8 offset:19456
    ds_read_b32 v125, v8 offset:20224
    ds_read_b32 v126, v8 offset:20992
    ds_read_b32 v127, v8 offset:21760
    ds_read_b32 v128, v8 offset:22528
    ds_read_b32 v129, v8 offset:23296
    ds_read_b32 v130, v8 offset:24064
    ds_read_b32 v131, v8 offset:24832
    ds_read_b32 v132, v8 offset:25600
    ds_read_b32 v133, v8 offset:26368
    ds_read_b32 v134, v8 offset:27136
    ds_read_b32 v135, v8 offset:27904
    s_waitcnt lgkmcnt(0)
    v_add_f32 v12, v104, v105
    v_add_f32 v12, v12, v106
    v_add_f32 v12, v12, v107
    v_add_f32 v12, v12, v108
    v_add_f32 v12, v12, v109
    v_add_f32 v12, v12, v110
    v_add_f32 v12, v12, v111
    v_fmac_f32 v11, v96, v12
    v_add_f32 v12, v112, v113
    v_add_f32 v12, v12, v114
    v_add_f32 v12, v12, v115
    v_add_f32 v12, v12, v116
    v_add_f32 v12, v12, v117
    v_add_f32 v12, v12, v118
    v_add_f32 v12, v12, v119
    v_fmac_f32 v11, v97, v12
    v_add_f32 v12, v120, v121
    v_add_f32 v12, v12, v122
    v_add_f32 v12, v12, v123
    v_add_f32 v12, v12, v124
    v_add_f32 v12, v12, v125
    v_add_f32 v12, v12, v126
    v_add_f32 v12, v12, v127
    v_fmac_f32 v11, v98, v12
    v_add_f32 v12, v128, v129
    v_add_f32 v12, v12, v130
    v_add_f32 v12, v12, v131
    v_add_f32 v12, v12, v132
    v_add_f32 v12, v12, v133
    v_add_f32 v12, v12, v134
    v_add_f32 v12, v12, v135
    v_fmac_f32 v11, v99, v12
    ds_read_b32 v104, v8 offset:28672
    ds_read_b32 v105, v8 offset:29440
    ds_read_b32 v106, v8 offset:30208
    ds_read_b32 v107, v8 offset:30976
    ds_read_b32 v108, v8 offset:31744
    ds_read_b32 v109, v8 offset:32512
    ds_read_b32 v110, v8 offset:33280
    ds_read_b32 v111, v8 offset:34048
    ds_read_b32 v112, v8 offset:34816
    ds_read_b32 v113, v8 offset:35584
    ds_read_b32 v114, v8 offset:36352
    ds_read_b32 v115, v8 offset:37120
    ds_read_b32 v116, v8 offset:37888
    ds_read_b32 v117, v8 offset:38656
    ds_read_b32 v118, v8 offset:39424
    ds_read_b32 v119, v8 offset:40192
    ds_read_b32 v120, v8 offset:40960
    ds_read_b32 v121, v8 offset:41728
    ds_read_b32 v122, v8 offset:42496
    ds_read_b32 v123, v8 offset:43264
    ds_read_b32 v124, v8 offset:44032
    ds_read_b32 v125, v8 offset:44800
    ds_read_b32 v126, v8 offset:45568
    ds_read_b32 v127, v8 offset:46336
    ds_read_b32 v128, v8 offset:47104
    ds_read_b32 v129, v8 offset:47872
    ds_read_b32 v130, v8 offset:48640
    ds_read_b32 v131, v8 offset:49408
    ds_read_b32 v132, v8 offset:50176
    ds_read_b32 v133, v8 offset:50944
    ds_read_b32 v134, v8 offset:51712
    ds_read_b32 v135, v8 offset:52480
    s_waitcnt lgkmcnt(0)
    v_add_f32 v12, v104, v105
    v_add_f32 v12, v12, v106
    v_add_f32 v12, v12, v107
    v_add_f32 v12, v12, v108
    v_add_f32 v12, v12, v109
    v_add_f32 v12, v12, v110
    v_add_f32 v12, v12, v111
    v_fmac_f32 v11, v100, v12
    v_add_f32 v12, v112, v113
    v_add_f32 v12, v12, v114
    v_add_f32 v12, v12, v115
    v_add_f32 v12, v12, v116
    v_add_f32 v12, v12, v117
    v_add_f32 v12, v12, v118
    v_add_f32 v12, v12, v119
    v_fmac_f32 v11, v101, v12
    v_add_f32 v12, v120, v121
    v_add_f32 v12, v12, v122
    v_add_f32 v12, v12, v123
    v_add_f32 v12, v12, v124
    v_add_f32 v12, v12, v125
    v_add_f32 v12, v12, v126
    v_add_f32 v12, v12, v127
    v_fmac_f32 v11, v102, v12
    v_add_f32 v12, v128, v129
    v_add_f32 v12, v12, v130
    v_add_f32 v12, v12, v131
    v_add_f32 v12, v12, v132
    v_add_f32 v12, v12, v133
    v_add_f32 v12, v12, v134
    v_add_f32 v12, v12, v135
    v_fmac_f32 v11, v103, v12
    s_lshl_b32 s40, s17, 5
    s_add_u32 s40, s40, s15
    s_lshl_b32 s40, s40, 2
    s_add_u32 s40, s40, s18
    s_lshl_b32 s40, s40, 10
    buffer_store_dword v11, v8, s[36:39], s40 offen offset:0 sc1
    v_mov_b32 v12, v9
    v_mov_b32 v13, v10
    v_cmp_eq_u32 vcc, 0, v0
    s_and_saveexec_b64 s[42:43], vcc
    buffer_store_dwordx2 v[12:13], v8, s[36:39], s40 offen offset:768 sc1
    s_mov_b64 exec, s[42:43]

L_att_fin:
    s_barrier
    s_cmp_ge_u32 s16, 20
    s_cbranch_scc1 L_ffn

    s_lshr_b32 s40, s14, 2
    s_and_b32 s41, s14, 3
    s_lshl_b32 s42, s40, 5
    s_lshl_b32 s43, s19, 2
    s_add_u32 s42, s42, s43
    s_add_u32 s42, s42, s41
    s_lshl_b32 s42, s42, 12
    v_lshlrev_b32 v8, 2, v1
    v_mov_b32 v9, 0

    s_mov_b32 s47, 0
L_pollA0:
    buffer_load_dwordx2 v[80:81], v9, s[36:39], s42 offen offset:768 sc1
    buffer_load_dwordx2 v[82:83], v9, s[36:39], s42 offen offset:1792 sc1
    buffer_load_dwordx2 v[84:85], v9, s[36:39], s42 offen offset:2816 sc1
    buffer_load_dwordx2 v[86:87], v9, s[36:39], s42 offen offset:3840 sc1
    s_waitcnt vmcnt(0)
    v_max_u32 v100, v80, v81
    v_max_u32 v100, v100, v82
    v_max_u32 v100, v100, v83
    v_max_u32 v100, v100, v84
    v_max_u32 v100, v100, v85
    v_max_u32 v100, v100, v86
    v_max_u32 v100, v100, v87
    v_cmp_eq_u32 vcc, -1, v100
    s_nop 3
    s_cmp_eq_u64 vcc, 0
    s_cbranch_scc1 L_pollA0_done
    s_add_u32 s47, s47, 1
    s_cmp_ge_u32 s47, 100000
    s_cbranch_scc1 L_pollA0_done
    s_sleep 2
    s_branch L_pollA0

L_pollA0_done:
    s_mov_b32 s47, 0
L_pollA:
    buffer_load_dwordx2 v[80:81], v9, s[36:39], s42 offen offset:768 sc1
    buffer_load_dword v88, v8, s[36:39], s42 offen offset:0 sc1
    buffer_load_dword v89, v8, s[36:39], s42 offen offset:256 sc1
    buffer_load_dword v90, v8, s[36:39], s42 offen offset:512 sc1
    buffer_load_dwordx2 v[82:83], v9, s[36:39], s42 offen offset:1792 sc1
    buffer_load_dword v91, v8, s[36:39], s42 offen offset:1024 sc1
    buffer_load_dword v92, v8, s[36:39], s42 offen offset:1280 sc1
    buffer_load_dword v93, v8, s[36:39], s42 offen offset:1536 sc1
    buffer_load_dwordx2 v[84:85], v9, s[36:39], s42 offen offset:2816 sc1
    buffer_load_dword v94, v8, s[36:39], s42 offen offset:2048 sc1
    buffer_load_dword v95, v8, s[36:39], s42 offen offset:2304 sc1
    buffer_load_dword v96, v8, s[36:39], s42 offen offset:2560 sc1
    buffer_load_dwordx2 v[86:87], v9, s[36:39], s42 offen offset:3840 sc1
    buffer_load_dword v97, v8, s[36:39], s42 offen offset:3072 sc1
    buffer_load_dword v98, v8, s[36:39], s42 offen offset:3328 sc1
    buffer_load_dword v99, v8, s[36:39], s42 offen offset:3584 sc1
    s_waitcnt vmcnt(0)
    v_max_u32 v100, v80, v81
    v_max_u32 v100, v100, v82
    v_max_u32 v100, v100, v83
    v_max_u32 v100, v100, v84
    v_max_u32 v100, v100, v85
    v_max_u32 v100, v100, v86
    v_max_u32 v100, v100, v87
    v_max_u32 v100, v100, v88
    v_max_u32 v100, v100, v89
    v_max_u32 v100, v100, v90
    v_max_u32 v100, v100, v91
    v_max_u32 v100, v100, v92
    v_max_u32 v100, v100, v93
    v_max_u32 v100, v100, v94
    v_max_u32 v100, v100, v95
    v_max_u32 v100, v100, v96
    v_max_u32 v100, v100, v97
    v_max_u32 v100, v100, v98
    v_max_u32 v100, v100, v99
    v_cmp_eq_u32 vcc, -1, v100
    s_nop 3
    s_cmp_eq_u64 vcc, 0
    s_cbranch_scc1 L_pollA_done
    s_add_u32 s47, s47, 1
    s_cmp_ge_u32 s47, 100000
    s_cbranch_scc1 L_pollA_done
    s_sleep 1
    s_branch L_pollA

L_pollA_done:
    v_max_f32 v100, v80, v82
    v_max_f32 v100, v100, v84
    v_max_f32 v100, v100, v86

    v_sub_f32 v101, v80, v100
    v_mul_f32 v101, 1069066811, v101
    v_exp_f32 v101, v101

    v_sub_f32 v102, v82, v100
    v_mul_f32 v102, 1069066811, v102
    v_exp_f32 v102, v102

    v_sub_f32 v103, v84, v100
    v_mul_f32 v103, 1069066811, v103
    v_exp_f32 v103, v103

    v_sub_f32 v104, v86, v100
    v_mul_f32 v104, 1069066811, v104
    v_exp_f32 v104, v104

    s_nop 0
    v_mul_f32 v105, v101, v81
    v_fmac_f32 v105, v102, v83
    v_fmac_f32 v105, v103, v85
    v_fmac_f32 v105, v104, v87
    v_rcp_f32 v105, v105

    s_mul_i32 s43, s40, 3072
    s_mul_i32 s44, s41, 768
    s_add_u32 s43, s43, s44
    v_add_u32 v9, s43, v8

    v_mul_f32 v106, v101, v88
    v_fmac_f32 v106, v102, v91
    v_fmac_f32 v106, v103, v94
    v_fmac_f32 v106, v104, v97
    v_mul_f32 v106, v106, v105

    v_cvt_pk_bf16_f32 v106, v106, v106
    v_lshlrev_b32 v106, 16, v106

    ds_write_b32 v9, v106 offset:0
    v_mul_f32 v107, v101, v89
    v_fmac_f32 v107, v102, v92
    v_fmac_f32 v107, v103, v95
    v_fmac_f32 v107, v104, v98
    v_mul_f32 v107, v107, v105

    v_cvt_pk_bf16_f32 v107, v107, v107
    v_lshlrev_b32 v107, 16, v107

    ds_write_b32 v9, v107 offset:256
    v_mul_f32 v108, v101, v90
    v_fmac_f32 v108, v102, v93
    v_fmac_f32 v108, v103, v96
    v_fmac_f32 v108, v104, v99
    v_mul_f32 v108, v108, v105

    v_cvt_pk_bf16_f32 v108, v108, v108
    v_lshlrev_b32 v108, 16, v108

    ds_write_b32 v9, v108 offset:512
    s_waitcnt lgkmcnt(0)
    s_barrier
    v_lshrrev_b32 v8, 2, v0
    v_lshlrev_b32 v8, 2, v8

    v_mov_b32 v16, 0
    v_mov_b32 v17, 0
    v_mov_b32 v18, 0
    v_mov_b32 v19, 0
    v_mov_b32 v20, 0
    v_mov_b32 v21, 0
    v_mov_b32 v22, 0
    v_mov_b32 v23, 0
    v_mov_b32 v24, 0
    v_mov_b32 v25, 0
    v_mov_b32 v26, 0
    v_mov_b32 v27, 0
    v_mov_b32 v28, 0
    v_mov_b32 v29, 0
    v_mov_b32 v30, 0
    v_mov_b32 v31, 0
    ds_read_b32 v80, v8 offset:0
    ds_read_b32 v81, v8 offset:3072

    ds_read_b32 v82, v8 offset:512
    ds_read_b32 v83, v8 offset:3584

    ds_read_b32 v84, v8 offset:1024
    ds_read_b32 v85, v8 offset:4096

    ds_read_b32 v86, v8 offset:1536
    ds_read_b32 v87, v8 offset:4608

    ds_read_b32 v88, v8 offset:2048
    ds_read_b32 v89, v8 offset:5120

    ds_read_b32 v90, v8 offset:2560
    ds_read_b32 v91, v8 offset:5632

    s_waitcnt lgkmcnt(0)
    v_lshlrev_b32 v12, 16, v40
    v_and_b32 v13, 0xffff0000, v40
    v_fmac_f32 v16, v80, v12
    v_fmac_f32 v17, v80, v13
    v_fmac_f32 v24, v81, v12
    v_fmac_f32 v25, v81, v13

    v_lshlrev_b32 v12, 16, v41
    v_and_b32 v13, 0xffff0000, v41
    v_fmac_f32 v18, v80, v12
    v_fmac_f32 v19, v80, v13
    v_fmac_f32 v26, v81, v12
    v_fmac_f32 v27, v81, v13

    v_lshlrev_b32 v12, 16, v42
    v_and_b32 v13, 0xffff0000, v42
    v_fmac_f32 v20, v80, v12
    v_fmac_f32 v21, v80, v13
    v_fmac_f32 v28, v81, v12
    v_fmac_f32 v29, v81, v13

    v_lshlrev_b32 v12, 16, v43
    v_and_b32 v13, 0xffff0000, v43
    v_fmac_f32 v22, v80, v12
    v_fmac_f32 v23, v80, v13
    v_fmac_f32 v30, v81, v12
    v_fmac_f32 v31, v81, v13

    v_lshlrev_b32 v12, 16, v44
    v_and_b32 v13, 0xffff0000, v44
    v_fmac_f32 v16, v82, v12
    v_fmac_f32 v17, v82, v13
    v_fmac_f32 v24, v83, v12
    v_fmac_f32 v25, v83, v13

    v_lshlrev_b32 v12, 16, v45
    v_and_b32 v13, 0xffff0000, v45
    v_fmac_f32 v18, v82, v12
    v_fmac_f32 v19, v82, v13
    v_fmac_f32 v26, v83, v12
    v_fmac_f32 v27, v83, v13

    v_lshlrev_b32 v12, 16, v46
    v_and_b32 v13, 0xffff0000, v46
    v_fmac_f32 v20, v82, v12
    v_fmac_f32 v21, v82, v13
    v_fmac_f32 v28, v83, v12
    v_fmac_f32 v29, v83, v13

    v_lshlrev_b32 v12, 16, v47
    v_and_b32 v13, 0xffff0000, v47
    v_fmac_f32 v22, v82, v12
    v_fmac_f32 v23, v82, v13
    v_fmac_f32 v30, v83, v12
    v_fmac_f32 v31, v83, v13

    v_lshlrev_b32 v12, 16, v48
    v_and_b32 v13, 0xffff0000, v48
    v_fmac_f32 v16, v84, v12
    v_fmac_f32 v17, v84, v13
    v_fmac_f32 v24, v85, v12
    v_fmac_f32 v25, v85, v13

    v_lshlrev_b32 v12, 16, v49
    v_and_b32 v13, 0xffff0000, v49
    v_fmac_f32 v18, v84, v12
    v_fmac_f32 v19, v84, v13
    v_fmac_f32 v26, v85, v12
    v_fmac_f32 v27, v85, v13

    v_lshlrev_b32 v12, 16, v50
    v_and_b32 v13, 0xffff0000, v50
    v_fmac_f32 v20, v84, v12
    v_fmac_f32 v21, v84, v13
    v_fmac_f32 v28, v85, v12
    v_fmac_f32 v29, v85, v13

    v_lshlrev_b32 v12, 16, v51
    v_and_b32 v13, 0xffff0000, v51
    v_fmac_f32 v22, v84, v12
    v_fmac_f32 v23, v84, v13
    v_fmac_f32 v30, v85, v12
    v_fmac_f32 v31, v85, v13

    v_lshlrev_b32 v12, 16, v52
    v_and_b32 v13, 0xffff0000, v52
    v_fmac_f32 v16, v86, v12
    v_fmac_f32 v17, v86, v13
    v_fmac_f32 v24, v87, v12
    v_fmac_f32 v25, v87, v13

    v_lshlrev_b32 v12, 16, v53
    v_and_b32 v13, 0xffff0000, v53
    v_fmac_f32 v18, v86, v12
    v_fmac_f32 v19, v86, v13
    v_fmac_f32 v26, v87, v12
    v_fmac_f32 v27, v87, v13

    v_lshlrev_b32 v12, 16, v54
    v_and_b32 v13, 0xffff0000, v54
    v_fmac_f32 v20, v86, v12
    v_fmac_f32 v21, v86, v13
    v_fmac_f32 v28, v87, v12
    v_fmac_f32 v29, v87, v13

    v_lshlrev_b32 v12, 16, v55
    v_and_b32 v13, 0xffff0000, v55
    v_fmac_f32 v22, v86, v12
    v_fmac_f32 v23, v86, v13
    v_fmac_f32 v30, v87, v12
    v_fmac_f32 v31, v87, v13

    v_lshlrev_b32 v12, 16, v56
    v_and_b32 v13, 0xffff0000, v56
    v_fmac_f32 v16, v88, v12
    v_fmac_f32 v17, v88, v13
    v_fmac_f32 v24, v89, v12
    v_fmac_f32 v25, v89, v13

    v_lshlrev_b32 v12, 16, v57
    v_and_b32 v13, 0xffff0000, v57
    v_fmac_f32 v18, v88, v12
    v_fmac_f32 v19, v88, v13
    v_fmac_f32 v26, v89, v12
    v_fmac_f32 v27, v89, v13

    v_lshlrev_b32 v12, 16, v58
    v_and_b32 v13, 0xffff0000, v58
    v_fmac_f32 v20, v88, v12
    v_fmac_f32 v21, v88, v13
    v_fmac_f32 v28, v89, v12
    v_fmac_f32 v29, v89, v13

    v_lshlrev_b32 v12, 16, v59
    v_and_b32 v13, 0xffff0000, v59
    v_fmac_f32 v22, v88, v12
    v_fmac_f32 v23, v88, v13
    v_fmac_f32 v30, v89, v12
    v_fmac_f32 v31, v89, v13

    v_lshlrev_b32 v12, 16, v60
    v_and_b32 v13, 0xffff0000, v60
    v_fmac_f32 v16, v90, v12
    v_fmac_f32 v17, v90, v13
    v_fmac_f32 v24, v91, v12
    v_fmac_f32 v25, v91, v13

    v_lshlrev_b32 v12, 16, v61
    v_and_b32 v13, 0xffff0000, v61
    v_fmac_f32 v18, v90, v12
    v_fmac_f32 v19, v90, v13
    v_fmac_f32 v26, v91, v12
    v_fmac_f32 v27, v91, v13

    v_lshlrev_b32 v12, 16, v62
    v_and_b32 v13, 0xffff0000, v62
    v_fmac_f32 v20, v90, v12
    v_fmac_f32 v21, v90, v13
    v_fmac_f32 v28, v91, v12
    v_fmac_f32 v29, v91, v13

    v_lshlrev_b32 v12, 16, v63
    v_and_b32 v13, 0xffff0000, v63
    v_fmac_f32 v22, v90, v12
    v_fmac_f32 v23, v90, v13
    v_fmac_f32 v30, v91, v12
    v_fmac_f32 v31, v91, v13

    v_lshlrev_b32 v8, 6, v0
    ds_write_b128 v8, v[16:19] offset:8192
    ds_write_b128 v8, v[20:23] offset:8208
    ds_write_b128 v8, v[24:27] offset:8224
    ds_write_b128 v8, v[28:31] offset:8240
    s_waitcnt lgkmcnt(0)
    s_barrier
    v_lshrrev_b32 v8, 3, v0
    v_and_b32 v9, 7, v0
    v_lshrrev_b32 v10, 5, v8
    v_and_b32 v11, 31, v8
    v_lshrrev_b32 v12, 3, v11
    v_and_b32 v13, 7, v11
    v_lshlrev_b32 v14, 12, v9
    v_lshlrev_b32 v12, 6, v12
    v_add_u32 v14, v14, v12
    v_lshlrev_b32 v12, 5, v10
    v_add_u32 v14, v14, v12
    v_lshlrev_b32 v13, 2, v13
    v_add_u32 v14, v14, v13

    ds_read_b32 v16, v14 offset:8192
    ds_read_b32 v17, v14 offset:8448
    ds_read_b32 v18, v14 offset:8704
    ds_read_b32 v19, v14 offset:8960
    ds_read_b32 v20, v14 offset:9216
    ds_read_b32 v21, v14 offset:9472
    ds_read_b32 v22, v14 offset:9728
    ds_read_b32 v23, v14 offset:9984
    ds_read_b32 v24, v14 offset:10240
    ds_read_b32 v25, v14 offset:10496
    ds_read_b32 v26, v14 offset:10752
    ds_read_b32 v27, v14 offset:11008
    ds_read_b32 v28, v14 offset:11264
    ds_read_b32 v29, v14 offset:11520
    ds_read_b32 v30, v14 offset:11776
    ds_read_b32 v31, v14 offset:12032
    s_waitcnt lgkmcnt(0)
    v_add_f32 v16, v16, v17
    v_add_f32 v16, v16, v18
    v_add_f32 v16, v16, v19
    v_add_f32 v16, v16, v20
    v_add_f32 v16, v16, v21
    v_add_f32 v16, v16, v22
    v_add_f32 v16, v16, v23
    v_add_f32 v16, v16, v24
    v_add_f32 v16, v16, v25
    v_add_f32 v16, v16, v26
    v_add_f32 v16, v16, v27
    v_add_f32 v16, v16, v28
    v_add_f32 v16, v16, v29
    v_add_f32 v16, v16, v30
    v_add_f32 v16, v16, v31
    s_nop 1
    v_add_f32_dpp v17, v16, v16 quad_perm:[1,0,3,2] row_mask:0xf bank_mask:0xf
    s_nop 1
    v_add_f32_dpp v16, v17, v17 quad_perm:[2,3,0,1] row_mask:0xf bank_mask:0xf
    s_nop 1
    v_add_f32_dpp v17, v16, v16 row_half_mirror row_mask:0xf bank_mask:0xf
    s_nop 1
    v_mov_b32 v16, v17

    v_mul_u32_u24 v12, 640, v10
    v_add_u32 v12, v12, v11
    v_lshlrev_b32 v12, 2, v12
    s_mul_i32 s40, s19, 5120
    s_lshl_b32 s41, s16, 7
    s_add_u32 s40, s40, s41
    s_add_u32 s40, s40, 262144
    v_cmp_eq_u32 vcc, 0, v9
    s_and_saveexec_b64 s[42:43], vcc
    buffer_store_dword v16, v12, s[36:39], s40 offen sc1
    s_mov_b64 exec, s[42:43]

    s_cmp_ge_u32 s2, 40
    s_cbranch_scc1 L_end
    s_cmp_lg_u32 s14, 0
    s_cbranch_scc1 L_p4_light_done
    v_mul_u32_u24 v8, 5120, v1
    v_add_u32 v9, 64, v1
    v_min_u32 v9, 95, v9
    v_mul_u32_u24 v9, 5120, v9
    s_lshl_b32 s42, s2, 7
    s_add_u32 s42, s42, 327680

    s_mov_b32 s47, 0
L_pollC0:
    buffer_load_dword v16, v8, s[36:39], s42 offen sc1
    buffer_load_dword v17, v9, s[36:39], s42 offen sc1

    s_waitcnt vmcnt(0)
    v_max_u32 v18, v16, v17
    v_cmp_eq_u32 vcc, -1, v18
    s_nop 3
    s_cmp_eq_u64 vcc, 0
    s_cbranch_scc1 L_pollC0_done
    s_add_u32 s47, s47, 1
    s_cmp_ge_u32 s47, 100000
    s_cbranch_scc1 L_pollC0_done
    s_sleep 4
    s_branch L_pollC0

L_pollC0_done:
L_p4_light_done:
    s_barrier
    v_and_b32 v8, 31, v0
    v_lshrrev_b32 v9, 5, v0
    s_lshl_b32 s40, s2, 5
    v_add_u32 v10, s40, v8
    v_lshlrev_b32 v11, 2, v10
    v_mul_u32_u24 v12, 30720, v9
    v_add_u32 v12, v12, v11

    s_mov_b32 s47, 0
L_pollC:
    s_mov_b32 s41, 327680
    buffer_load_dword v16, v12, s[36:39], s41 offen sc1
    s_add_u32 s41, s41, 5120
    buffer_load_dword v17, v12, s[36:39], s41 offen sc1
    s_add_u32 s41, s41, 5120
    buffer_load_dword v18, v12, s[36:39], s41 offen sc1
    s_add_u32 s41, s41, 5120
    buffer_load_dword v19, v12, s[36:39], s41 offen sc1
    s_add_u32 s41, s41, 5120
    buffer_load_dword v20, v12, s[36:39], s41 offen sc1
    s_add_u32 s41, s41, 5120
    buffer_load_dword v21, v12, s[36:39], s41 offen sc1
    s_mov_b32 s41, 851968
    buffer_load_dword v22, v11, s[36:39], s41 offen sc1

    s_waitcnt vmcnt(0)
    v_max_u32 v23, v16, v17
    v_max_u32 v23, v23, v18
    v_max_u32 v23, v23, v19
    v_max_u32 v23, v23, v20
    v_max_u32 v23, v23, v21
    v_max_u32 v23, v23, v22
    v_cmp_eq_u32 vcc, -1, v23
    s_nop 3
    s_cmp_eq_u64 vcc, 0
    s_cbranch_scc1 L_pollC_done
    s_add_u32 s47, s47, 1
    s_cmp_ge_u32 s47, 100000
    s_cbranch_scc1 L_pollC_done
    s_sleep 2
    s_branch L_pollC

L_pollC_done:
    v_add_f32 v16, v16, v17
    v_add_f32 v16, v16, v18
    v_add_f32 v16, v16, v19
    v_add_f32 v16, v16, v20
    v_add_f32 v16, v16, v21
    v_lshlrev_b32 v13, 2, v0
    ds_write_b32 v13, v16
    s_waitcnt lgkmcnt(0)
    s_barrier
    v_cmp_gt_u32 vcc, 32, v0
    s_and_saveexec_b64 s[42:43], vcc
    s_cbranch_execz L_end

    ds_read_b32 v24, v13 offset:0
    ds_read_b32 v25, v13 offset:128
    ds_read_b32 v26, v13 offset:256
    ds_read_b32 v27, v13 offset:384
    ds_read_b32 v28, v13 offset:512
    ds_read_b32 v29, v13 offset:640
    ds_read_b32 v30, v13 offset:768
    ds_read_b32 v31, v13 offset:896
    ds_read_b32 v32, v13 offset:1024
    ds_read_b32 v33, v13 offset:1152
    ds_read_b32 v34, v13 offset:1280
    ds_read_b32 v35, v13 offset:1408
    ds_read_b32 v36, v13 offset:1536
    ds_read_b32 v37, v13 offset:1664
    ds_read_b32 v38, v13 offset:1792
    ds_read_b32 v39, v13 offset:1920
    s_waitcnt lgkmcnt(0)
    v_add_f32 v24, v24, v25
    v_add_f32 v24, v24, v26
    v_add_f32 v24, v24, v27
    v_add_f32 v24, v24, v28
    v_add_f32 v24, v24, v29
    v_add_f32 v24, v24, v30
    v_add_f32 v24, v24, v31
    v_add_f32 v24, v24, v32
    v_add_f32 v24, v24, v33
    v_add_f32 v24, v24, v34
    v_add_f32 v24, v24, v35
    v_add_f32 v24, v24, v36
    v_add_f32 v24, v24, v37
    v_add_f32 v24, v24, v38
    v_add_f32 v24, v24, v39
    v_cvt_pk_bf16_f32 v24, v24, v24
    v_lshlrev_b32 v24, 16, v24

    v_add_f32 v24, v24, v22
    v_cvt_pk_bf16_f32 v24, v24, v24
    v_lshlrev_b32 v14, 1, v10
    buffer_store_short v24, v14, s[68:71], 0 offen
    s_branch L_end

L_ffn:
    v_and_b32 v8, 1, v0
    v_lshrrev_b32 v9, 1, v0
    v_and_b32 v9, 127, v9
    v_mul_u32_u24 v9, 3072, v9
    v_lshlrev_b32 v8, 4, v8
    v_add_u32 v9, v9, v8
    s_lshl_b32 s40, s13, 5

    buffer_load_dwordx4 v[40:43], v9, s[48:51], s40 offen nt
    s_add_u32 s40, s40, 393216
    buffer_load_dwordx4 v[44:47], v9, s[48:51], s40 offen nt
    s_add_u32 s40, s40, 393216
    buffer_load_dwordx4 v[48:51], v9, s[48:51], s40 offen nt
    s_add_u32 s40, s40, 393216
    buffer_load_dwordx4 v[52:55], v9, s[48:51], s40 offen nt
    s_add_u32 s40, s40, 393216
    buffer_load_dwordx4 v[56:59], v9, s[48:51], s40 offen nt
    v_mul_u32_u24 v8, 205, v0
    v_lshrrev_b32 v8, 14, v8
    v_mul_u32_u24 v9, 80, v8
    v_sub_u32 v9, v0, v9
    v_mul_u32_u24 v8, 1280, v8
    v_lshlrev_b32 v9, 4, v9
    v_add_u32 v9, v9, v8
    s_mul_i32 s40, s13, 20480

    buffer_load_dwordx4 v[60:63], v9, s[64:67], s40 offen nt
    s_add_u32 s40, s40, 7680
    buffer_load_dwordx4 v[64:67], v9, s[64:67], s40 offen nt
    s_add_u32 s40, s40, 7680
    buffer_load_dwordx4 v[68:71], v9, s[64:67], s40 offen nt
    v_add_u32 v14, 0, v0
    v_min_u32 v14, 1279, v14
    v_lshlrev_b32 v8, 2, v14
    v_lshlrev_b32 v14, 1, v14
    buffer_load_ushort v11, v14, s[20:23], 0 offen

    v_add_u32 v14, 512, v0
    v_min_u32 v14, 1279, v14
    v_lshlrev_b32 v9, 2, v14
    v_lshlrev_b32 v14, 1, v14
    buffer_load_ushort v12, v14, s[20:23], 0 offen

    v_add_u32 v14, 1024, v0
    v_min_u32 v14, 1279, v14
    v_lshlrev_b32 v10, 2, v14
    v_lshlrev_b32 v14, 1, v14
    buffer_load_ushort v13, v14, s[20:23], 0 offen

    s_cmp_lg_u32 s14, 0
    s_cbranch_scc1 L_p3_light_done

    v_add_u32 v14, 0, v1
    v_min_u32 v14, 159, v14
    v_and_b32 v15, 7, v14
    v_lshrrev_b32 v14, 3, v14
    v_mul_u32_u24 v15, 5120, v15
    v_lshlrev_b32 v14, 7, v14
    v_add_u32 v104, v14, v15

    v_add_u32 v14, 64, v1
    v_min_u32 v14, 159, v14
    v_and_b32 v15, 7, v14
    v_lshrrev_b32 v14, 3, v14
    v_mul_u32_u24 v15, 5120, v15
    v_lshlrev_b32 v14, 7, v14
    v_add_u32 v105, v14, v15

    v_add_u32 v14, 128, v1
    v_min_u32 v14, 159, v14
    v_and_b32 v15, 7, v14
    v_lshrrev_b32 v14, 3, v14
    v_mul_u32_u24 v15, 5120, v15
    v_lshlrev_b32 v14, 7, v14
    v_add_u32 v106, v14, v15

    s_mov_b32 s47, 0
L_pollB0:
    s_mov_b32 s40, 262144
    buffer_load_dword v108, v104, s[36:39], s40 offen sc1
    buffer_load_dword v109, v105, s[36:39], s40 offen sc1
    buffer_load_dword v110, v106, s[36:39], s40 offen sc1
    s_waitcnt vmcnt(0)
    v_max_u32 v14, v108, v109
    v_max_u32 v14, v14, v110
    v_cmp_eq_u32 vcc, -1, v14
    s_nop 3
    s_cmp_eq_u64 vcc, 0
    s_cbranch_scc1 L_pollB0_done
    s_add_u32 s47, s47, 1
    s_cmp_ge_u32 s47, 100000
    s_cbranch_scc1 L_pollB0_done
    s_sleep 4
    s_branch L_pollB0

L_pollB0_done:
L_p3_light_done:
    s_barrier
    s_mov_b32 s47, 0
L_pollB:
    s_mov_b32 s40, 262144
    buffer_load_dword v80, v8, s[36:39], s40 offen sc1
    buffer_load_dword v81, v9, s[36:39], s40 offen sc1
    buffer_load_dword v82, v10, s[36:39], s40 offen sc1
    s_add_u32 s40, s40, 5120
    buffer_load_dword v83, v8, s[36:39], s40 offen sc1
    buffer_load_dword v84, v9, s[36:39], s40 offen sc1
    buffer_load_dword v85, v10, s[36:39], s40 offen sc1
    s_add_u32 s40, s40, 5120
    buffer_load_dword v86, v8, s[36:39], s40 offen sc1
    buffer_load_dword v87, v9, s[36:39], s40 offen sc1
    buffer_load_dword v88, v10, s[36:39], s40 offen sc1
    s_add_u32 s40, s40, 5120
    buffer_load_dword v89, v8, s[36:39], s40 offen sc1
    buffer_load_dword v90, v9, s[36:39], s40 offen sc1
    buffer_load_dword v91, v10, s[36:39], s40 offen sc1
    s_add_u32 s40, s40, 5120
    buffer_load_dword v92, v8, s[36:39], s40 offen sc1
    buffer_load_dword v93, v9, s[36:39], s40 offen sc1
    buffer_load_dword v94, v10, s[36:39], s40 offen sc1
    s_add_u32 s40, s40, 5120
    buffer_load_dword v95, v8, s[36:39], s40 offen sc1
    buffer_load_dword v96, v9, s[36:39], s40 offen sc1
    buffer_load_dword v97, v10, s[36:39], s40 offen sc1
    s_add_u32 s40, s40, 5120
    buffer_load_dword v98, v8, s[36:39], s40 offen sc1
    buffer_load_dword v99, v9, s[36:39], s40 offen sc1
    buffer_load_dword v100, v10, s[36:39], s40 offen sc1
    s_add_u32 s40, s40, 5120
    buffer_load_dword v101, v8, s[36:39], s40 offen sc1
    buffer_load_dword v102, v9, s[36:39], s40 offen sc1
    buffer_load_dword v103, v10, s[36:39], s40 offen sc1
    s_waitcnt vmcnt(0)
    v_max_u32 v14, v80, v81
    v_max_u32 v14, v14, v82
    v_max_u32 v14, v14, v83
    v_max_u32 v14, v14, v84
    v_max_u32 v14, v14, v85
    v_max_u32 v14, v14, v86
    v_max_u32 v14, v14, v87
    v_max_u32 v14, v14, v88
    v_max_u32 v14, v14, v89
    v_max_u32 v14, v14, v90
    v_max_u32 v14, v14, v91
    v_max_u32 v14, v14, v92
    v_max_u32 v14, v14, v93
    v_max_u32 v14, v14, v94
    v_max_u32 v14, v14, v95
    v_max_u32 v14, v14, v96
    v_max_u32 v14, v14, v97
    v_max_u32 v14, v14, v98
    v_max_u32 v14, v14, v99
    v_max_u32 v14, v14, v100
    v_max_u32 v14, v14, v101
    v_max_u32 v14, v14, v102
    v_max_u32 v14, v14, v103
    v_cmp_eq_u32 vcc, -1, v14
    s_nop 3
    s_cmp_eq_u64 vcc, 0
    s_cbranch_scc1 L_pollB_done
    s_add_u32 s47, s47, 1
    s_cmp_ge_u32 s47, 100000
    s_cbranch_scc1 L_pollB_done
    s_sleep 4
    s_branch L_pollB

L_pollB_done:
    v_add_f32 v80, v80, v83
    v_add_f32 v80, v80, v86
    v_add_f32 v80, v80, v89
    v_add_f32 v80, v80, v92
    v_add_f32 v80, v80, v95
    v_add_f32 v80, v80, v98
    v_add_f32 v80, v80, v101
    v_cvt_pk_bf16_f32 v80, v80, v80
    v_lshlrev_b32 v80, 16, v80

    v_lshlrev_b32 v11, 16, v11
    v_add_f32 v80, v80, v11

    v_cvt_pk_bf16_f32 v80, v80, v80
    v_lshlrev_b32 v80, 16, v80

    ds_write_b32 v8, v80 offset:0
    v_add_f32 v81, v81, v84
    v_add_f32 v81, v81, v87
    v_add_f32 v81, v81, v90
    v_add_f32 v81, v81, v93
    v_add_f32 v81, v81, v96
    v_add_f32 v81, v81, v99
    v_add_f32 v81, v81, v102
    v_cvt_pk_bf16_f32 v81, v81, v81
    v_lshlrev_b32 v81, 16, v81

    v_lshlrev_b32 v12, 16, v12
    v_add_f32 v81, v81, v12

    v_cvt_pk_bf16_f32 v81, v81, v81
    v_lshlrev_b32 v81, 16, v81

    ds_write_b32 v9, v81 offset:0
    v_add_f32 v82, v82, v85
    v_add_f32 v82, v82, v88
    v_add_f32 v82, v82, v91
    v_add_f32 v82, v82, v94
    v_add_f32 v82, v82, v97
    v_add_f32 v82, v82, v100
    v_add_f32 v82, v82, v103
    v_cvt_pk_bf16_f32 v82, v82, v82
    v_lshlrev_b32 v82, 16, v82

    v_lshlrev_b32 v13, 16, v13
    v_add_f32 v82, v82, v13

    v_cvt_pk_bf16_f32 v82, v82, v82
    v_lshlrev_b32 v82, 16, v82

    ds_write_b32 v10, v82 offset:0
    s_cmp_lg_u32 s13, 0
    s_cbranch_scc1 L_noh
    s_mov_b32 s40, 851968

    buffer_store_dword v80, v8, s[36:39], s40 offen sc1
    buffer_store_dword v81, v9, s[36:39], s40 offen sc1
    buffer_store_dword v82, v10, s[36:39], s40 offen sc1
L_noh:
    s_waitcnt lgkmcnt(0)
    s_barrier
    v_lshlrev_b32 v14, 2, v1

    ds_read_b32 v104, v14 offset:0
    ds_read_b32 v105, v14 offset:256
    ds_read_b32 v106, v14 offset:512
    ds_read_b32 v107, v14 offset:768
    ds_read_b32 v108, v14 offset:1024
    ds_read_b32 v109, v14 offset:1280
    ds_read_b32 v110, v14 offset:1536
    ds_read_b32 v111, v14 offset:1792
    ds_read_b32 v112, v14 offset:2048
    ds_read_b32 v113, v14 offset:2304
    ds_read_b32 v114, v14 offset:2560
    ds_read_b32 v115, v14 offset:2816
    ds_read_b32 v116, v14 offset:3072
    ds_read_b32 v117, v14 offset:3328
    ds_read_b32 v118, v14 offset:3584
    ds_read_b32 v119, v14 offset:3840
    ds_read_b32 v120, v14 offset:4096
    ds_read_b32 v121, v14 offset:4352
    ds_read_b32 v122, v14 offset:4608
    ds_read_b32 v123, v14 offset:4864
    s_waitcnt lgkmcnt(0)
    v_add_f32 v26, v104, v105
    v_add_f32 v26, v26, v106
    v_add_f32 v26, v26, v107
    v_add_f32 v26, v26, v108
    v_add_f32 v26, v26, v109
    v_add_f32 v26, v26, v110
    v_add_f32 v26, v26, v111
    v_add_f32 v26, v26, v112
    v_add_f32 v26, v26, v113
    s_nop 1
    v_add_f32_dpp v27, v26, v26 quad_perm:[1,0,3,2] row_mask:0xf bank_mask:0xf
    s_nop 1
    v_add_f32_dpp v26, v27, v27 quad_perm:[2,3,0,1] row_mask:0xf bank_mask:0xf
    s_nop 1
    v_add_f32_dpp v27, v26, v26 row_half_mirror row_mask:0xf bank_mask:0xf
    s_nop 1
    v_add_f32_dpp v26, v27, v27 row_mirror row_mask:0xf bank_mask:0xf
    s_nop 1
    v_readlane_b32 s44, v26, 0
    v_readlane_b32 s45, v26, 16
    v_readlane_b32 s46, v26, 32
    v_readlane_b32 s47, v26, 48
    s_nop 1
    v_mov_b32 v26, s44
    v_add_f32 v26, s45, v26
    v_add_f32 v26, s46, v26
    v_add_f32 v26, s47, v26

    v_mul_f32 v26, 986500301, v26
    v_mov_b32 v76, v26

    v_cvt_pk_bf16_f32 v76, v76, v76
    v_lshlrev_b32 v76, 16, v76

    v_sub_f32 v27, v104, v26
    v_mul_f32 v78, v27, v27

    v_sub_f32 v27, v105, v26
    v_fmac_f32 v78, v27, v27

    v_sub_f32 v27, v106, v26
    v_fmac_f32 v78, v27, v27

    v_sub_f32 v27, v107, v26
    v_fmac_f32 v78, v27, v27

    v_sub_f32 v27, v108, v26
    v_fmac_f32 v78, v27, v27

    v_sub_f32 v27, v109, v26
    v_fmac_f32 v78, v27, v27

    v_sub_f32 v27, v110, v26
    v_fmac_f32 v78, v27, v27

    v_sub_f32 v27, v111, v26
    v_fmac_f32 v78, v27, v27

    v_sub_f32 v27, v112, v26
    v_fmac_f32 v78, v27, v27

    v_sub_f32 v27, v113, v26
    v_fmac_f32 v78, v27, v27

    s_nop 1
    v_add_f32_dpp v27, v78, v78 quad_perm:[1,0,3,2] row_mask:0xf bank_mask:0xf
    s_nop 1
    v_add_f32_dpp v78, v27, v27 quad_perm:[2,3,0,1] row_mask:0xf bank_mask:0xf
    s_nop 1
    v_add_f32_dpp v27, v78, v78 row_half_mirror row_mask:0xf bank_mask:0xf
    s_nop 1
    v_add_f32_dpp v78, v27, v27 row_mirror row_mask:0xf bank_mask:0xf
    s_nop 1
    v_readlane_b32 s44, v78, 0
    v_readlane_b32 s45, v78, 16
    v_readlane_b32 s46, v78, 32
    v_readlane_b32 s47, v78, 48
    s_nop 1
    v_mov_b32 v78, s44
    v_add_f32 v78, s45, v78
    v_add_f32 v78, s46, v78
    v_add_f32 v78, s47, v78

    v_mul_f32 v78, 986500301, v78
    v_cvt_pk_bf16_f32 v78, v78, v78
    v_lshlrev_b32 v78, 16, v78

    v_add_f32 v78, 925353388, v78
    v_cvt_pk_bf16_f32 v78, v78, v78
    v_lshlrev_b32 v78, 16, v78

    v_sqrt_f32 v78, v78
    s_nop 0
    v_cvt_pk_bf16_f32 v78, v78, v78
    v_lshlrev_b32 v78, 16, v78

    v_rcp_f32 v78, v78
    s_nop 0
    v_add_f32 v26, v114, v115
    v_add_f32 v26, v26, v116
    v_add_f32 v26, v26, v117
    v_add_f32 v26, v26, v118
    v_add_f32 v26, v26, v119
    v_add_f32 v26, v26, v120
    v_add_f32 v26, v26, v121
    v_add_f32 v26, v26, v122
    v_add_f32 v26, v26, v123
    s_nop 1
    v_add_f32_dpp v27, v26, v26 quad_perm:[1,0,3,2] row_mask:0xf bank_mask:0xf
    s_nop 1
    v_add_f32_dpp v26, v27, v27 quad_perm:[2,3,0,1] row_mask:0xf bank_mask:0xf
    s_nop 1
    v_add_f32_dpp v27, v26, v26 row_half_mirror row_mask:0xf bank_mask:0xf
    s_nop 1
    v_add_f32_dpp v26, v27, v27 row_mirror row_mask:0xf bank_mask:0xf
    s_nop 1
    v_readlane_b32 s44, v26, 0
    v_readlane_b32 s45, v26, 16
    v_readlane_b32 s46, v26, 32
    v_readlane_b32 s47, v26, 48
    s_nop 1
    v_mov_b32 v26, s44
    v_add_f32 v26, s45, v26
    v_add_f32 v26, s46, v26
    v_add_f32 v26, s47, v26

    v_mul_f32 v26, 986500301, v26
    v_mov_b32 v77, v26

    v_cvt_pk_bf16_f32 v77, v77, v77
    v_lshlrev_b32 v77, 16, v77

    v_sub_f32 v27, v114, v26
    v_mul_f32 v79, v27, v27

    v_sub_f32 v27, v115, v26
    v_fmac_f32 v79, v27, v27

    v_sub_f32 v27, v116, v26
    v_fmac_f32 v79, v27, v27

    v_sub_f32 v27, v117, v26
    v_fmac_f32 v79, v27, v27

    v_sub_f32 v27, v118, v26
    v_fmac_f32 v79, v27, v27

    v_sub_f32 v27, v119, v26
    v_fmac_f32 v79, v27, v27

    v_sub_f32 v27, v120, v26
    v_fmac_f32 v79, v27, v27

    v_sub_f32 v27, v121, v26
    v_fmac_f32 v79, v27, v27

    v_sub_f32 v27, v122, v26
    v_fmac_f32 v79, v27, v27

    v_sub_f32 v27, v123, v26
    v_fmac_f32 v79, v27, v27

    s_nop 1
    v_add_f32_dpp v27, v79, v79 quad_perm:[1,0,3,2] row_mask:0xf bank_mask:0xf
    s_nop 1
    v_add_f32_dpp v79, v27, v27 quad_perm:[2,3,0,1] row_mask:0xf bank_mask:0xf
    s_nop 1
    v_add_f32_dpp v27, v79, v79 row_half_mirror row_mask:0xf bank_mask:0xf
    s_nop 1
    v_add_f32_dpp v79, v27, v27 row_mirror row_mask:0xf bank_mask:0xf
    s_nop 1
    v_readlane_b32 s44, v79, 0
    v_readlane_b32 s45, v79, 16
    v_readlane_b32 s46, v79, 32
    v_readlane_b32 s47, v79, 48
    s_nop 1
    v_mov_b32 v79, s44
    v_add_f32 v79, s45, v79
    v_add_f32 v79, s46, v79
    v_add_f32 v79, s47, v79

    v_mul_f32 v79, 986500301, v79
    v_cvt_pk_bf16_f32 v79, v79, v79
    v_lshlrev_b32 v79, 16, v79

    v_add_f32 v79, 925353388, v79
    v_cvt_pk_bf16_f32 v79, v79, v79
    v_lshlrev_b32 v79, 16, v79

    v_sqrt_f32 v79, v79
    s_nop 0
    v_cvt_pk_bf16_f32 v79, v79, v79
    v_lshlrev_b32 v79, 16, v79

    v_rcp_f32 v79, v79
    s_nop 0
    v_mov_b32 v16, 0
    v_mov_b32 v17, 0
    v_mov_b32 v18, 0
    v_mov_b32 v19, 0
    v_mov_b32 v20, 0
    v_mov_b32 v21, 0
    v_mov_b32 v22, 0
    v_mov_b32 v23, 0
    v_mov_b32 v24, 0
    v_mov_b32 v25, 0
    v_mov_b32 v26, 0
    v_mov_b32 v27, 0
    v_mov_b32 v28, 0
    v_mov_b32 v29, 0
    v_mov_b32 v30, 0
    v_mov_b32 v31, 0
    v_lshrrev_b32 v14, 1, v0
    v_and_b32 v14, 127, v14
    v_lshlrev_b32 v14, 2, v14

    ds_read_b32 v104, v14 offset:0
    ds_read_b32 v105, v14 offset:2560

    ds_read_b32 v106, v14 offset:512
    ds_read_b32 v107, v14 offset:3072

    ds_read_b32 v108, v14 offset:1024
    ds_read_b32 v109, v14 offset:3584

    ds_read_b32 v110, v14 offset:1536
    ds_read_b32 v111, v14 offset:4096

    ds_read_b32 v112, v14 offset:2048
    ds_read_b32 v113, v14 offset:4608

    s_waitcnt lgkmcnt(0)
    v_sub_f32 v104, v104, v76
    v_cvt_pk_bf16_f32 v104, v104, v104
    v_lshlrev_b32 v104, 16, v104

    v_mul_f32 v104, v104, v78
    v_cvt_pk_bf16_f32 v104, v104, v104
    v_lshlrev_b32 v104, 16, v104

    v_sub_f32 v105, v105, v77
    v_cvt_pk_bf16_f32 v105, v105, v105
    v_lshlrev_b32 v105, 16, v105

    v_mul_f32 v105, v105, v79
    v_cvt_pk_bf16_f32 v105, v105, v105
    v_lshlrev_b32 v105, 16, v105

    v_lshlrev_b32 v34, 16, v40
    v_and_b32 v35, 0xffff0000, v40
    v_fmac_f32 v16, v104, v34
    v_fmac_f32 v17, v104, v35
    v_fmac_f32 v24, v105, v34
    v_fmac_f32 v25, v105, v35

    v_lshlrev_b32 v34, 16, v41
    v_and_b32 v35, 0xffff0000, v41
    v_fmac_f32 v18, v104, v34
    v_fmac_f32 v19, v104, v35
    v_fmac_f32 v26, v105, v34
    v_fmac_f32 v27, v105, v35

    v_lshlrev_b32 v34, 16, v42
    v_and_b32 v35, 0xffff0000, v42
    v_fmac_f32 v20, v104, v34
    v_fmac_f32 v21, v104, v35
    v_fmac_f32 v28, v105, v34
    v_fmac_f32 v29, v105, v35

    v_lshlrev_b32 v34, 16, v43
    v_and_b32 v35, 0xffff0000, v43
    v_fmac_f32 v22, v104, v34
    v_fmac_f32 v23, v104, v35
    v_fmac_f32 v30, v105, v34
    v_fmac_f32 v31, v105, v35

    v_sub_f32 v106, v106, v76
    v_cvt_pk_bf16_f32 v106, v106, v106
    v_lshlrev_b32 v106, 16, v106

    v_mul_f32 v106, v106, v78
    v_cvt_pk_bf16_f32 v106, v106, v106
    v_lshlrev_b32 v106, 16, v106

    v_sub_f32 v107, v107, v77
    v_cvt_pk_bf16_f32 v107, v107, v107
    v_lshlrev_b32 v107, 16, v107

    v_mul_f32 v107, v107, v79
    v_cvt_pk_bf16_f32 v107, v107, v107
    v_lshlrev_b32 v107, 16, v107

    v_lshlrev_b32 v34, 16, v44
    v_and_b32 v35, 0xffff0000, v44
    v_fmac_f32 v16, v106, v34
    v_fmac_f32 v17, v106, v35
    v_fmac_f32 v24, v107, v34
    v_fmac_f32 v25, v107, v35

    v_lshlrev_b32 v34, 16, v45
    v_and_b32 v35, 0xffff0000, v45
    v_fmac_f32 v18, v106, v34
    v_fmac_f32 v19, v106, v35
    v_fmac_f32 v26, v107, v34
    v_fmac_f32 v27, v107, v35

    v_lshlrev_b32 v34, 16, v46
    v_and_b32 v35, 0xffff0000, v46
    v_fmac_f32 v20, v106, v34
    v_fmac_f32 v21, v106, v35
    v_fmac_f32 v28, v107, v34
    v_fmac_f32 v29, v107, v35

    v_lshlrev_b32 v34, 16, v47
    v_and_b32 v35, 0xffff0000, v47
    v_fmac_f32 v22, v106, v34
    v_fmac_f32 v23, v106, v35
    v_fmac_f32 v30, v107, v34
    v_fmac_f32 v31, v107, v35

    v_sub_f32 v108, v108, v76
    v_cvt_pk_bf16_f32 v108, v108, v108
    v_lshlrev_b32 v108, 16, v108

    v_mul_f32 v108, v108, v78
    v_cvt_pk_bf16_f32 v108, v108, v108
    v_lshlrev_b32 v108, 16, v108

    v_sub_f32 v109, v109, v77
    v_cvt_pk_bf16_f32 v109, v109, v109
    v_lshlrev_b32 v109, 16, v109

    v_mul_f32 v109, v109, v79
    v_cvt_pk_bf16_f32 v109, v109, v109
    v_lshlrev_b32 v109, 16, v109

    v_lshlrev_b32 v34, 16, v48
    v_and_b32 v35, 0xffff0000, v48
    v_fmac_f32 v16, v108, v34
    v_fmac_f32 v17, v108, v35
    v_fmac_f32 v24, v109, v34
    v_fmac_f32 v25, v109, v35

    v_lshlrev_b32 v34, 16, v49
    v_and_b32 v35, 0xffff0000, v49
    v_fmac_f32 v18, v108, v34
    v_fmac_f32 v19, v108, v35
    v_fmac_f32 v26, v109, v34
    v_fmac_f32 v27, v109, v35

    v_lshlrev_b32 v34, 16, v50
    v_and_b32 v35, 0xffff0000, v50
    v_fmac_f32 v20, v108, v34
    v_fmac_f32 v21, v108, v35
    v_fmac_f32 v28, v109, v34
    v_fmac_f32 v29, v109, v35

    v_lshlrev_b32 v34, 16, v51
    v_and_b32 v35, 0xffff0000, v51
    v_fmac_f32 v22, v108, v34
    v_fmac_f32 v23, v108, v35
    v_fmac_f32 v30, v109, v34
    v_fmac_f32 v31, v109, v35

    v_sub_f32 v110, v110, v76
    v_cvt_pk_bf16_f32 v110, v110, v110
    v_lshlrev_b32 v110, 16, v110

    v_mul_f32 v110, v110, v78
    v_cvt_pk_bf16_f32 v110, v110, v110
    v_lshlrev_b32 v110, 16, v110

    v_sub_f32 v111, v111, v77
    v_cvt_pk_bf16_f32 v111, v111, v111
    v_lshlrev_b32 v111, 16, v111

    v_mul_f32 v111, v111, v79
    v_cvt_pk_bf16_f32 v111, v111, v111
    v_lshlrev_b32 v111, 16, v111

    v_lshlrev_b32 v34, 16, v52
    v_and_b32 v35, 0xffff0000, v52
    v_fmac_f32 v16, v110, v34
    v_fmac_f32 v17, v110, v35
    v_fmac_f32 v24, v111, v34
    v_fmac_f32 v25, v111, v35

    v_lshlrev_b32 v34, 16, v53
    v_and_b32 v35, 0xffff0000, v53
    v_fmac_f32 v18, v110, v34
    v_fmac_f32 v19, v110, v35
    v_fmac_f32 v26, v111, v34
    v_fmac_f32 v27, v111, v35

    v_lshlrev_b32 v34, 16, v54
    v_and_b32 v35, 0xffff0000, v54
    v_fmac_f32 v20, v110, v34
    v_fmac_f32 v21, v110, v35
    v_fmac_f32 v28, v111, v34
    v_fmac_f32 v29, v111, v35

    v_lshlrev_b32 v34, 16, v55
    v_and_b32 v35, 0xffff0000, v55
    v_fmac_f32 v22, v110, v34
    v_fmac_f32 v23, v110, v35
    v_fmac_f32 v30, v111, v34
    v_fmac_f32 v31, v111, v35

    v_sub_f32 v112, v112, v76
    v_cvt_pk_bf16_f32 v112, v112, v112
    v_lshlrev_b32 v112, 16, v112

    v_mul_f32 v112, v112, v78
    v_cvt_pk_bf16_f32 v112, v112, v112
    v_lshlrev_b32 v112, 16, v112

    v_sub_f32 v113, v113, v77
    v_cvt_pk_bf16_f32 v113, v113, v113
    v_lshlrev_b32 v113, 16, v113

    v_mul_f32 v113, v113, v79
    v_cvt_pk_bf16_f32 v113, v113, v113
    v_lshlrev_b32 v113, 16, v113

    v_lshlrev_b32 v34, 16, v56
    v_and_b32 v35, 0xffff0000, v56
    v_fmac_f32 v16, v112, v34
    v_fmac_f32 v17, v112, v35
    v_fmac_f32 v24, v113, v34
    v_fmac_f32 v25, v113, v35

    v_lshlrev_b32 v34, 16, v57
    v_and_b32 v35, 0xffff0000, v57
    v_fmac_f32 v18, v112, v34
    v_fmac_f32 v19, v112, v35
    v_fmac_f32 v26, v113, v34
    v_fmac_f32 v27, v113, v35

    v_lshlrev_b32 v34, 16, v58
    v_and_b32 v35, 0xffff0000, v58
    v_fmac_f32 v20, v112, v34
    v_fmac_f32 v21, v112, v35
    v_fmac_f32 v28, v113, v34
    v_fmac_f32 v29, v113, v35

    v_lshlrev_b32 v34, 16, v59
    v_and_b32 v35, 0xffff0000, v59
    v_fmac_f32 v22, v112, v34
    v_fmac_f32 v23, v112, v35
    v_fmac_f32 v30, v113, v34
    v_fmac_f32 v31, v113, v35

    v_lshlrev_b32 v14, 6, v0
    ds_write_b128 v14, v[16:19] offset:8192
    ds_write_b128 v14, v[20:23] offset:8208
    ds_write_b128 v14, v[24:27] offset:8224
    ds_write_b128 v14, v[28:31] offset:8240
    s_waitcnt lgkmcnt(0)
    s_barrier
    v_lshrrev_b32 v14, 3, v0
    v_and_b32 v15, 7, v0
    v_lshrrev_b32 v32, 5, v14
    v_lshrrev_b32 v33, 4, v14
    v_and_b32 v33, 1, v33
    v_lshrrev_b32 v34, 3, v14
    v_and_b32 v34, 1, v34
    v_and_b32 v35, 7, v14
    v_lshlrev_b32 v36, 11, v15
    v_lshlrev_b32 v32, 14, v32
    v_add_u32 v36, v36, v32
    v_lshlrev_b32 v34, 6, v34
    v_add_u32 v36, v36, v34
    v_lshlrev_b32 v33, 5, v33
    v_add_u32 v36, v36, v33
    v_lshlrev_b32 v35, 2, v35
    v_add_u32 v36, v36, v35

    ds_read_b32 v16, v36 offset:8192
    ds_read_b32 v17, v36 offset:8320
    ds_read_b32 v18, v36 offset:8448
    ds_read_b32 v19, v36 offset:8576
    ds_read_b32 v20, v36 offset:8704
    ds_read_b32 v21, v36 offset:8832
    ds_read_b32 v22, v36 offset:8960
    ds_read_b32 v23, v36 offset:9088
    ds_read_b32 v24, v36 offset:9216
    ds_read_b32 v25, v36 offset:9344
    ds_read_b32 v26, v36 offset:9472
    ds_read_b32 v27, v36 offset:9600
    ds_read_b32 v28, v36 offset:9728
    ds_read_b32 v29, v36 offset:9856
    ds_read_b32 v30, v36 offset:9984
    ds_read_b32 v31, v36 offset:10112
    s_waitcnt lgkmcnt(0)
    v_add_f32 v16, v16, v17
    v_add_f32 v16, v16, v18
    v_add_f32 v16, v16, v19
    v_add_f32 v16, v16, v20
    v_add_f32 v16, v16, v21
    v_add_f32 v16, v16, v22
    v_add_f32 v16, v16, v23
    v_add_f32 v16, v16, v24
    v_add_f32 v16, v16, v25
    v_add_f32 v16, v16, v26
    v_add_f32 v16, v16, v27
    v_add_f32 v16, v16, v28
    v_add_f32 v16, v16, v29
    v_add_f32 v16, v16, v30
    v_add_f32 v16, v16, v31
    s_nop 1
    v_add_f32_dpp v17, v16, v16 quad_perm:[1,0,3,2] row_mask:0xf bank_mask:0xf
    s_nop 1
    v_add_f32_dpp v16, v17, v17 quad_perm:[2,3,0,1] row_mask:0xf bank_mask:0xf
    s_nop 1
    v_add_f32_dpp v17, v16, v16 row_half_mirror row_mask:0xf bank_mask:0xf
    s_nop 1
    v_mov_b32 v16, v17

    v_cvt_pk_bf16_f32 v16, v16, v16
    v_lshlrev_b32 v16, 16, v16

    v_lshlrev_b32 v32, 2, v14
    ds_write_b32 v32, v16 offset:5120
    s_waitcnt lgkmcnt(0)
    s_barrier
    s_cmp_lg_u32 s14, 0
    s_cbranch_scc1 L_act_done
    v_and_b32 v13, 15, v0
    v_lshrrev_b32 v14, 5, v0
    v_lshrrev_b32 v15, 4, v0
    v_and_b32 v15, 1, v15
    v_lshlrev_b32 v16, 6, v14
    v_lshlrev_b32 v17, 2, v13
    v_add_u32 v16, v16, v17
    ds_read_b32 v18, v16 offset:5120
    ds_read_b32 v19, v16 offset:5248
    s_waitcnt lgkmcnt(0)
    v_mul_f32 v20, v18, v18
    v_mul_f32 v20, v20, v18
    v_mov_b32 v21, 0x3d372713
    v_fma_f32 v20, v20, v21, v18
    v_mul_f32 v20, 0x3f4c422a, v20
    v_mul_f32 v20, 0x4038aa3b, v20
    v_exp_f32 v20, v20
    s_nop 0
    v_add_f32 v20, 1.0, v20
    v_rcp_f32 v20, v20
    s_nop 0
    v_fma_f32 v20, v20, -2.0, 1.0
    v_add_f32 v20, 1.0, v20
    v_mul_f32 v20, v20, v18
    v_mul_f32 v20, 0.5, v20

    v_cvt_pk_bf16_f32 v20, v20, v20
    v_lshlrev_b32 v20, 16, v20

    v_mul_f32 v20, v20, v19
    v_cvt_pk_bf16_f32 v20, v20, v20
    v_lshlrev_b32 v20, 16, v20

    v_cmp_eq_u32 vcc, 0, v15
    s_nop 1
    v_cndmask_b32 v20, 0, v20, vcc
    v_lshlrev_b32 v16, 2, v0
    ds_write_b32 v16, v20 offset:5376

L_act_done:
    s_waitcnt lgkmcnt(0)
    s_barrier
    v_mul_u32_u24 v14, 205, v0
    v_lshrrev_b32 v14, 14, v14
    v_lshlrev_b32 v14, 2, v14

    v_mov_b32 v16, 0
    v_mov_b32 v17, 0
    v_mov_b32 v18, 0
    v_mov_b32 v19, 0
    v_mov_b32 v20, 0
    v_mov_b32 v21, 0
    v_mov_b32 v22, 0
    v_mov_b32 v23, 0
    v_mov_b32 v24, 0
    v_mov_b32 v25, 0
    v_mov_b32 v26, 0
    v_mov_b32 v27, 0
    v_mov_b32 v28, 0
    v_mov_b32 v29, 0
    v_mov_b32 v30, 0
    v_mov_b32 v31, 0
    ds_read_b32 v104, v14 offset:5376
    ds_read_b32 v105, v14 offset:5504

    ds_read_b32 v106, v14 offset:5400
    ds_read_b32 v107, v14 offset:5528

    ds_read_b32 v108, v14 offset:5424
    ds_read_b32 v109, v14 offset:5552

    s_waitcnt lgkmcnt(0)
    v_lshlrev_b32 v34, 16, v60
    v_and_b32 v35, 0xffff0000, v60
    v_fmac_f32 v16, v104, v34
    v_fmac_f32 v17, v104, v35
    v_fmac_f32 v24, v105, v34
    v_fmac_f32 v25, v105, v35

    v_lshlrev_b32 v34, 16, v61
    v_and_b32 v35, 0xffff0000, v61
    v_fmac_f32 v18, v104, v34
    v_fmac_f32 v19, v104, v35
    v_fmac_f32 v26, v105, v34
    v_fmac_f32 v27, v105, v35

    v_lshlrev_b32 v34, 16, v62
    v_and_b32 v35, 0xffff0000, v62
    v_fmac_f32 v20, v104, v34
    v_fmac_f32 v21, v104, v35
    v_fmac_f32 v28, v105, v34
    v_fmac_f32 v29, v105, v35

    v_lshlrev_b32 v34, 16, v63
    v_and_b32 v35, 0xffff0000, v63
    v_fmac_f32 v22, v104, v34
    v_fmac_f32 v23, v104, v35
    v_fmac_f32 v30, v105, v34
    v_fmac_f32 v31, v105, v35

    v_lshlrev_b32 v34, 16, v64
    v_and_b32 v35, 0xffff0000, v64
    v_fmac_f32 v16, v106, v34
    v_fmac_f32 v17, v106, v35
    v_fmac_f32 v24, v107, v34
    v_fmac_f32 v25, v107, v35

    v_lshlrev_b32 v34, 16, v65
    v_and_b32 v35, 0xffff0000, v65
    v_fmac_f32 v18, v106, v34
    v_fmac_f32 v19, v106, v35
    v_fmac_f32 v26, v107, v34
    v_fmac_f32 v27, v107, v35

    v_lshlrev_b32 v34, 16, v66
    v_and_b32 v35, 0xffff0000, v66
    v_fmac_f32 v20, v106, v34
    v_fmac_f32 v21, v106, v35
    v_fmac_f32 v28, v107, v34
    v_fmac_f32 v29, v107, v35

    v_lshlrev_b32 v34, 16, v67
    v_and_b32 v35, 0xffff0000, v67
    v_fmac_f32 v22, v106, v34
    v_fmac_f32 v23, v106, v35
    v_fmac_f32 v30, v107, v34
    v_fmac_f32 v31, v107, v35

    v_lshlrev_b32 v34, 16, v68
    v_and_b32 v35, 0xffff0000, v68
    v_fmac_f32 v16, v108, v34
    v_fmac_f32 v17, v108, v35
    v_fmac_f32 v24, v109, v34
    v_fmac_f32 v25, v109, v35

    v_lshlrev_b32 v34, 16, v69
    v_and_b32 v35, 0xffff0000, v69
    v_fmac_f32 v18, v108, v34
    v_fmac_f32 v19, v108, v35
    v_fmac_f32 v26, v109, v34
    v_fmac_f32 v27, v109, v35

    v_lshlrev_b32 v34, 16, v70
    v_and_b32 v35, 0xffff0000, v70
    v_fmac_f32 v20, v108, v34
    v_fmac_f32 v21, v108, v35
    v_fmac_f32 v28, v109, v34
    v_fmac_f32 v29, v109, v35

    v_lshlrev_b32 v34, 16, v71
    v_and_b32 v35, 0xffff0000, v71
    v_fmac_f32 v22, v108, v34
    v_fmac_f32 v23, v108, v35
    v_fmac_f32 v30, v109, v34
    v_fmac_f32 v31, v109, v35

    v_cmp_gt_u32 vcc, 480, v0
    s_and_saveexec_b64 s[42:43], vcc
    v_lshlrev_b32 v14, 6, v0

    ds_write_b128 v14, v[16:19] offset:8192
    ds_write_b128 v14, v[20:23] offset:8208
    ds_write_b128 v14, v[24:27] offset:8224
    ds_write_b128 v14, v[28:31] offset:8240
    s_mov_b64 exec, s[42:43]
    s_waitcnt lgkmcnt(0)
    s_barrier
    s_mul_i32 s40, s13, 5120
    s_add_u32 s40, s40, 327680

    v_lshrrev_b32 v14, 2, v8
    v_cmp_le_u32 vcc, 640, v14
    s_nop 1
    v_cndmask_b32 v15, 0, 1, vcc
    v_mul_u32_u24 v32, 640, v15
    v_sub_u32 v14, v14, v32
    v_lshrrev_b32 v32, 3, v14
    v_and_b32 v33, 7, v14
    v_lshlrev_b32 v32, 6, v32
    v_lshlrev_b32 v33, 2, v33
    v_add_u32 v32, v32, v33
    v_lshlrev_b32 v15, 5, v15
    v_add_u32 v32, v32, v15

    ds_read_b32 v104, v32 offset:8192
    ds_read_b32 v105, v32 offset:13312
    ds_read_b32 v106, v32 offset:18432
    ds_read_b32 v107, v32 offset:23552
    ds_read_b32 v108, v32 offset:28672
    ds_read_b32 v109, v32 offset:33792
    v_lshrrev_b32 v14, 2, v9
    v_cmp_le_u32 vcc, 640, v14
    s_nop 1
    v_cndmask_b32 v15, 0, 1, vcc
    v_mul_u32_u24 v32, 640, v15
    v_sub_u32 v14, v14, v32
    v_lshrrev_b32 v32, 3, v14
    v_and_b32 v33, 7, v14
    v_lshlrev_b32 v32, 6, v32
    v_lshlrev_b32 v33, 2, v33
    v_add_u32 v32, v32, v33
    v_lshlrev_b32 v15, 5, v15
    v_add_u32 v32, v32, v15

    ds_read_b32 v110, v32 offset:8192
    ds_read_b32 v111, v32 offset:13312
    ds_read_b32 v112, v32 offset:18432
    ds_read_b32 v113, v32 offset:23552
    ds_read_b32 v114, v32 offset:28672
    ds_read_b32 v115, v32 offset:33792
    v_lshrrev_b32 v14, 2, v10
    v_cmp_le_u32 vcc, 640, v14
    s_nop 1
    v_cndmask_b32 v15, 0, 1, vcc
    v_mul_u32_u24 v32, 640, v15
    v_sub_u32 v14, v14, v32
    v_lshrrev_b32 v32, 3, v14
    v_and_b32 v33, 7, v14
    v_lshlrev_b32 v32, 6, v32
    v_lshlrev_b32 v33, 2, v33
    v_add_u32 v32, v32, v33
    v_lshlrev_b32 v15, 5, v15
    v_add_u32 v32, v32, v15

    ds_read_b32 v116, v32 offset:8192
    ds_read_b32 v117, v32 offset:13312
    ds_read_b32 v118, v32 offset:18432
    ds_read_b32 v119, v32 offset:23552
    ds_read_b32 v120, v32 offset:28672
    ds_read_b32 v121, v32 offset:33792
    s_waitcnt lgkmcnt(0)
    v_add_f32 v104, v104, v105
    v_add_f32 v104, v104, v106
    v_add_f32 v104, v104, v107
    v_add_f32 v104, v104, v108
    v_add_f32 v104, v104, v109
    buffer_store_dword v104, v8, s[36:39], s40 offen sc1
    v_add_f32 v110, v110, v111
    v_add_f32 v110, v110, v112
    v_add_f32 v110, v110, v113
    v_add_f32 v110, v110, v114
    v_add_f32 v110, v110, v115
    buffer_store_dword v110, v9, s[36:39], s40 offen sc1
    v_add_f32 v116, v116, v117
    v_add_f32 v116, v116, v118
    v_add_f32 v116, v116, v119
    v_add_f32 v116, v116, v120
    v_add_f32 v116, v116, v121
    buffer_store_dword v116, v10, s[36:39], s40 offen sc1
L_end:
    s_endpgm
.section .rodata,"a"
.p2align 6
.amdhsa_kernel sequential_preLN__sliding_block_cached__geglu_ffn__decode_kernel
  .amdhsa_next_free_vgpr 256
  .amdhsa_next_free_sgpr 102
  .amdhsa_accum_offset 256
  .amdhsa_group_segment_fixed_size 0
  .amdhsa_kernarg_size 96
  .amdhsa_user_sgpr_count 2
  .amdhsa_user_sgpr_kernarg_segment_ptr 1
  .amdhsa_system_sgpr_workgroup_id_x 1
.end_amdhsa_kernel
```
